```python
import torch

def _softmax(x, axis=-1):
    return torch.softmax(x, dim=axis)
def _gelu(x):
    return torch.nn.functional.gelu(x, approximate="tanh")
def _silu(x):
    return torch.nn.functional.silu(x)
def _sigmoid(x):
    return torch.sigmoid(x)
def _layernorm(x, axis=-1, eps=1e-5):
    m = x.mean(dim=axis, keepdim=True)
    v = x.var(dim=axis, keepdim=True, unbiased=False)
    return (x - m) / torch.sqrt(v + eps)
def _scatter_add(tgt, idx, src, axis=0):
    return tgt.clone().index_add_(axis, idx, src)
def _segment_sum(src, seg, n):
    out = torch.zeros((n,) + src.shape[1:], dtype=src.dtype)
    return out.index_add_(0, seg, src)
def _pad(x, pw):
    flat = tuple(v for pair in reversed(pw) for v in pair)
    return torch.nn.functional.pad(x, flat)

kernel_name = 'standalone__dense_activation_gelu__prompt'

def setup_inputs():

    _w = (lambda a: (lambda t: t.to(torch.bfloat16) if t.is_floating_point() else t)(torch.as_tensor(a)))
    B, S, D, F = 1, 2048, 512, 1376
    return {
        "x": _w((lambda *s: torch.randn(*s, dtype=torch.bfloat16) * 0.05)(B, S, D)),
        "w1": _w((lambda *s: torch.randn(*s, dtype=torch.bfloat16) * 3.2)(D, F) * (D ** -0.5)),
        "b1": _w((lambda *s: torch.randn(*s, dtype=torch.bfloat16) * 3.2)(F) * 0.01),
        "w2": _w((lambda *s: torch.randn(*s, dtype=torch.bfloat16) * 0.05)(F, D) * (F ** -0.5)),
        "b2": _w((lambda *s: torch.randn(*s, dtype=torch.bfloat16) * 0.1)(D) * 0.01),
    }

def reference(x, w1, b1, w2, b2):
    h = torch.einsum("bsd,df->bsf", x, w1) + b1
    h = _gelu(h)
    return torch.einsum("bsf,fd->bsd", h, w2) + b2
```

```asm
; @launch grid=(256,1,1) block=(512,1,1) lds=163840
.amdgcn_target "amdgcn-amd-amdhsa--gfx950"
.text
.p2align 12
.globl standalone__dense_activation_gelu__prompt_kernel
.p2align 8
.type standalone__dense_activation_gelu__prompt_kernel,@function
standalone__dense_activation_gelu__prompt_kernel:
    s_load_dwordx16 s[8:23], s[0:1], 0
    s_cmp_ge_u32 s2, 256
    s_cbranch_scc1 L_END
    v_lshrrev_b32 v2, 6, v0
    v_and_b32 v1, 63, v0
    s_and_b32 s3, s2, 7
    v_readfirstlane_b32 s7, v2
    s_bfe_u32 s4, s2, 0x30003
    s_lshr_b32 s5, s2, 6
    s_and_b32 s6, s3, 3
    s_lshl_b32 s30, s5, 2
    s_add_u32 s6, s6, s30
    s_lshr_b32 s24, s3, 2
    s_lshl_b32 s24, s24, 3
    s_add_u32 s24, s24, s4
    s_and_b32 s28, s7, 3
    v_and_b32 v2, 3, v2
    s_cmp_lt_u32 s7, 4
    s_cbranch_scc1 L_C
    s_add_u32 s62, s5, s4
    s_and_b32 s62, s62, 1
    s_lshl_b32 s62, s62, 2
    s_lshr_b32 s30, s3, 2
    s_add_u32 s30, s30, s3
    s_and_b32 s30, s30, 1
    s_lshl_b32 s30, s30, 1
    s_add_u32 s62, s62, s30
    v_lshrrev_b32 v3, 3, v1
    v_lshl_add_u32 v3, v2, 5, v3
    v_lshlrev_b32 v3, 10, v3
    v_lshrrev_b32 v4, 4, v1
    v_and_b32 v5, 7, v1
    v_xor_b32 v4, v4, v5
    v_lshl_add_u32 v44, v4, 4, v3
    v_xor_b32 v4, 4, v4
    v_lshl_add_u32 v45, v4, 4, v3
    v_add_u32 v45, 7168, v45
    v_add_u32 v46, 14336, v44
    v_add_u32 v47, 14336, v45
    s_nop 0
    s_lshl_b32 s56, s28, 12
    s_lshl_b32 s59, s6, 17
    s_cmp_eq_u32 s24, 15
    s_cselect_b32 s34, 0, 131072
    s_mov_b32 s35, 0x20000
    s_waitcnt lgkmcnt(0)
    s_add_u32 s32, s8, s59
    s_addc_u32 s33, s9, 0
    s_add_u32 m0, s56, 0
    s_lshl_b32 s63, s62, 7
    buffer_load_dwordx4 v44, s[32:35], s63 offen offset:0 lds
    buffer_load_dwordx4 v45, s[32:35], s63 offen offset:1024 lds
    buffer_load_dwordx4 v46, s[32:35], s63 offen offset:2048 lds
    buffer_load_dwordx4 v47, s[32:35], s63 offen offset:3072 lds
    v_mul_u32_u24 v3, 192, v2
    v_add_u32 v3, v3, v1
    v_mul_u32_u24 v4, 43691, v3
    v_lshrrev_b32 v4, 19, v4
    v_mul_u32_u24 v5, 12, v4
    v_sub_u32 v5, v3, v5
    v_lshrrev_b32 v24, 2, v4
    v_and_b32 v24, 2, v24
    v_xor_b32 v5, v5, v24
    v_mul_u32_u24 v4, 2752, v4
    v_lshl_add_u32 v48, v5, 4, v4
    v_add_u32 v3, 64, v3
    v_mul_u32_u24 v4, 43691, v3
    v_lshrrev_b32 v4, 19, v4
    v_mul_u32_u24 v5, 12, v4
    v_sub_u32 v5, v3, v5
    v_lshrrev_b32 v24, 2, v4
    v_and_b32 v24, 2, v24
    v_xor_b32 v5, v5, v24
    v_mul_u32_u24 v4, 2752, v4
    v_lshl_add_u32 v49, v5, 4, v4
    v_subrev_u32 v49, 1024, v49
    v_add_u32 v3, 64, v3
    v_mul_u32_u24 v4, 43691, v3
    v_lshrrev_b32 v4, 19, v4
    v_mul_u32_u24 v5, 12, v4
    v_sub_u32 v5, v3, v5
    v_lshrrev_b32 v24, 2, v4
    v_and_b32 v24, 2, v24
    v_xor_b32 v5, v5, v24
    v_mul_u32_u24 v4, 2752, v4
    v_lshl_add_u32 v50, v5, 4, v4
    v_subrev_u32 v50, 2048, v50
    s_mul_i32 s57, s28, 3072
    s_add_u32 s57, s57, 16384
    s_mul_i32 s58, s24, 192
    s_sub_u32 s38, 1409024, s58
    s_cmp_eq_u32 s24, 15
    s_cselect_b32 s38, 0, s38
    s_mov_b32 s39, 0x20000
    s_add_u32 s36, s10, s58
    s_addc_u32 s37, s11, 0
    s_add_u32 m0, s57, 0
    s_mul_i32 s63, s62, 176128
    s_add_u32 s62, s62, 1
    s_and_b32 s62, s62, 7
    buffer_load_dwordx4 v48, s[36:39], s63 offen offset:0 lds
    buffer_load_dwordx4 v49, s[36:39], s63 offen offset:1024 lds
    buffer_load_dwordx4 v50, s[36:39], s63 offen offset:2048 lds
    s_add_u32 m0, s56, 28672
    s_lshl_b32 s63, s62, 7
    buffer_load_dwordx4 v44, s[32:35], s63 offen offset:0 lds
    buffer_load_dwordx4 v45, s[32:35], s63 offen offset:1024 lds
    buffer_load_dwordx4 v46, s[32:35], s63 offen offset:2048 lds
    buffer_load_dwordx4 v47, s[32:35], s63 offen offset:3072 lds
    s_add_u32 s30, s3, 1
    s_and_b32 s30, s30, 3
    s_lshl_b32 s30, s30, 1
    s_lshl_b32 s25, s5, 3
    s_add_u32 s25, s25, s30
    s_lshr_b32 s30, s3, 2
    s_add_u32 s25, s25, s30
    s_lshr_b32 s29, s7, 2
    s_lshl_b32 s26, s28, 12
    s_mul_i32 s27, s28, 11
    v_lshrrev_b32 v3, 2, v1
    v_lshlrev_b32 v3, 7, v3
    v_bfe_u32 v4, v1, 3, 2
    v_lshl_add_u32 v3, v4, 5, v3
    v_and_b32 v4, 3, v1
    v_lshl_add_u32 v3, v4, 3, v3
    v_lshl_add_u32 v6, v2, 12, v3
    v_xor_b32 v7, 32, v6
    v_xor_b32 v8, 64, v6
    v_xor_b32 v9, 0x60, v6
    v_add_u32 v10, 65536, v6
    v_add_u32 v11, 65536, v7
    v_add_u32 v12, 65536, v8
    v_add_u32 v13, 65536, v9
    v_add_u32 v14, 131072, v6
    v_add_u32 v15, 131072, v7
    v_add_u32 v16, 131072, v8
    v_add_u32 v17, 131072, v9
    v_lshlrev_b32 v18, 4, v1
    s_cmp_eq_u32 s29, 0
    s_cselect_b32 s30, 131072, 0
    v_and_b32 v3, 15, v1
    v_lshrrev_b32 v4, 4, v1
    v_and_b32 v5, 7, v1
    v_xor_b32 v4, v4, v5
    v_lshlrev_b32 v4, 4, v4
    v_lshl_add_u32 v4, v3, 8, v4
    v_lshl_add_u32 v4, v2, 13, v4
    v_add_u32 v19, s30, v4
    v_xor_b32 v20, 64, v19
    v_lshrrev_b32 v3, 3, v1
    v_lshlrev_b32 v4, 1, v5
    v_xor_b32 v4, v4, v3
    v_lshlrev_b32 v4, 4, v4
    v_lshl_add_u32 v3, v2, 3, v3
    v_lshl_add_u32 v4, v3, 8, v4
    v_add_u32 v21, s30, v4
    v_xor_b32 v22, 16, v21
    v_lshlrev_b32 v5, 4, v5
    v_lshl_add_u32 v23, v3, 10, v5
    v_and_b32 v3, 31, v1
    v_lshlrev_b32 v25, 2, v3
    v_and_b32 v26, 15, v1
    v_lshlrev_b32 v26, 2, v26
    s_lshl_b32 s30, s25, 1
    s_add_u32 s30, s30, s29
    s_mul_i32 s68, s30, 90112
    s_lshl_b32 s69, s4, 7
    s_lshl_b32 s67, s30, 15
    s_add_u32 s67, s67, s69
    s_mov_b32 s40, s22
    s_mov_b32 s41, s23
    s_mov_b32 s42, 5767168
    s_mov_b32 s43, 0x20000
    s_mov_b32 s44, s20
    s_mov_b32 s45, s21
    s_mov_b32 s46, 256
    s_mov_b32 s47, 0x20000
    s_add_u32 s52, s18, s67
    s_addc_u32 s53, s19, 0
    s_sub_u32 s54, 2097152, s67
    s_mov_b32 s55, 0x20000
    v_lshrrev_b32 v3, 3, v1
    v_bfe_u32 v4, v1, 4, 2
    v_lshlrev_b32 v4, 1, v4
    v_and_b32 v5, 7, v1
    v_xor_b32 v4, v4, v5
    v_lshlrev_b32 v3, 10, v3
    v_lshl_add_u32 v51, v4, 4, v3
    v_add_u32 v52, 7168, v51
    v_add_u32 v53, 14336, v51
    v_add_u32 v54, 21504, v51
    s_lshl_b32 s30, s4, 7
    s_add_u32 s48, s14, s30
    s_addc_u32 s49, s15, 0
    s_sub_u32 s50, 1409024, s30
    s_mov_b32 s51, 0x20000
    s_lshl_b32 s30, s2, 2
    s_add_u32 s30, s30, s28
    s_mul_i32 s30, s30, 1376
    s_and_b32 s30, s30, 0xffffffc0
    s_add_u32 s58, s14, s30
    s_addc_u32 s59, s15, 0
    s_lshr_b32 s30, s2, 3
    s_mul_i32 s30, s30, 43
    s_mul_i32 s31, s28, 11
    s_add_u32 s30, s30, s31
    s_min_u32 s30, s30, 1365
    s_lshl_b32 s30, s30, 10
    s_add_u32 s60, s14, s30
    s_addc_u32 s61, s15, 0
    s_add_u32 m0, s57, 28672
    s_mul_i32 s63, s62, 176128
    s_add_u32 s62, s62, 1
    s_and_b32 s62, s62, 7
    buffer_load_dwordx4 v48, s[36:39], s63 offen offset:0 lds
    buffer_load_dwordx4 v49, s[36:39], s63 offen offset:1024 lds
    buffer_load_dwordx4 v50, s[36:39], s63 offen offset:2048 lds
    s_add_u32 m0, s56, 57344
    s_lshl_b32 s63, s62, 7
    buffer_load_dwordx4 v44, s[32:35], s63 offen offset:0 lds
    buffer_load_dwordx4 v45, s[32:35], s63 offen offset:1024 lds
    buffer_load_dwordx4 v46, s[32:35], s63 offen offset:2048 lds
    buffer_load_dwordx4 v47, s[32:35], s63 offen offset:3072 lds
    s_waitcnt vmcnt(11)
    s_barrier
    s_add_u32 m0, s57, 57344
    s_mul_i32 s63, s62, 176128
    s_add_u32 s62, s62, 1
    s_and_b32 s62, s62, 7
    buffer_load_dwordx4 v48, s[36:39], s63 offen offset:0 lds
    buffer_load_dwordx4 v49, s[36:39], s63 offen offset:1024 lds
    buffer_load_dwordx4 v50, s[36:39], s63 offen offset:2048 lds
    s_add_u32 m0, s56, 86016
    s_lshl_b32 s63, s62, 7
    buffer_load_dwordx4 v44, s[32:35], s63 offen offset:0 lds
    buffer_load_dwordx4 v45, s[32:35], s63 offen offset:1024 lds
    buffer_load_dwordx4 v46, s[32:35], s63 offen offset:2048 lds
    buffer_load_dwordx4 v47, s[32:35], s63 offen offset:3072 lds
    s_waitcnt vmcnt(11)
    s_barrier
    s_load_dword s31, s[60:61], 384
    s_load_dword s31, s[58:59], 0
    s_load_dword s31, s[60:61], 448
    s_load_dword s31, s[58:59], 64
    s_load_dword s31, s[60:61], 1408
    s_load_dword s31, s[58:59], 128
    s_load_dword s31, s[60:61], 1472
    s_load_dword s31, s[58:59], 192
    s_load_dword s31, s[60:61], 2432
    s_load_dword s31, s[58:59], 256
    s_load_dword s31, s[60:61], 2496
    s_add_u32 m0, s57, 86016
    s_mul_i32 s63, s62, 176128
    s_add_u32 s62, s62, 1
    s_and_b32 s62, s62, 7
    buffer_load_dwordx4 v48, s[36:39], s63 offen offset:0 lds
    buffer_load_dwordx4 v49, s[36:39], s63 offen offset:1024 lds
    buffer_load_dwordx4 v50, s[36:39], s63 offen offset:2048 lds
    s_add_u32 m0, s56, 0
    s_lshl_b32 s63, s62, 7
    buffer_load_dwordx4 v44, s[32:35], s63 offen offset:0 lds
    buffer_load_dwordx4 v45, s[32:35], s63 offen offset:1024 lds
    buffer_load_dwordx4 v46, s[32:35], s63 offen offset:2048 lds
    buffer_load_dwordx4 v47, s[32:35], s63 offen offset:3072 lds
    s_waitcnt vmcnt(11)
    s_barrier
    s_load_dword s31, s[58:59], 320
    s_load_dword s31, s[60:61], 3456
    s_load_dword s31, s[58:59], 384
    s_load_dword s31, s[60:61], 3520
    s_load_dword s31, s[58:59], 448
    s_load_dword s31, s[60:61], 4480
    s_load_dword s31, s[58:59], 512
    s_load_dword s31, s[60:61], 4544
    s_load_dword s31, s[58:59], 576
    s_load_dword s31, s[60:61], 5504
    s_load_dword s31, s[58:59], 640
    s_add_u32 m0, s57, 0
    s_mul_i32 s63, s62, 176128
    s_add_u32 s62, s62, 1
    s_and_b32 s62, s62, 7
    buffer_load_dwordx4 v48, s[36:39], s63 offen offset:0 lds
    buffer_load_dwordx4 v49, s[36:39], s63 offen offset:1024 lds
    buffer_load_dwordx4 v50, s[36:39], s63 offen offset:2048 lds
    s_add_u32 m0, s56, 28672
    s_lshl_b32 s63, s62, 7
    buffer_load_dwordx4 v44, s[32:35], s63 offen offset:0 lds
    buffer_load_dwordx4 v45, s[32:35], s63 offen offset:1024 lds
    buffer_load_dwordx4 v46, s[32:35], s63 offen offset:2048 lds
    buffer_load_dwordx4 v47, s[32:35], s63 offen offset:3072 lds
    s_waitcnt vmcnt(11)
    s_barrier
    s_load_dword s31, s[60:61], 5568
    s_load_dword s31, s[58:59], 704
    s_load_dword s31, s[60:61], 6528
    s_load_dword s31, s[58:59], 768
    s_load_dword s31, s[60:61], 6592
    s_load_dword s31, s[58:59], 832
    s_load_dword s31, s[60:61], 7552
    s_load_dword s31, s[58:59], 896
    s_load_dword s31, s[60:61], 7616
    s_load_dword s31, s[58:59], 960
    s_load_dword s31, s[60:61], 8576
    s_add_u32 m0, s57, 28672
    s_mul_i32 s63, s62, 176128
    s_add_u32 s62, s62, 1
    s_and_b32 s62, s62, 7
    buffer_load_dwordx4 v48, s[36:39], s63 offen offset:0 lds
    buffer_load_dwordx4 v49, s[36:39], s63 offen offset:1024 lds
    buffer_load_dwordx4 v50, s[36:39], s63 offen offset:2048 lds
    s_add_u32 m0, s56, 57344
    s_lshl_b32 s63, s62, 7
    buffer_load_dwordx4 v44, s[32:35], s63 offen offset:0 lds
    buffer_load_dwordx4 v45, s[32:35], s63 offen offset:1024 lds
    buffer_load_dwordx4 v46, s[32:35], s63 offen offset:2048 lds
    buffer_load_dwordx4 v47, s[32:35], s63 offen offset:3072 lds
    s_waitcnt vmcnt(11)
    s_barrier
    s_load_dword s31, s[58:59], 1024
    s_load_dword s31, s[60:61], 8640
    s_load_dword s31, s[58:59], 1088
    s_load_dword s31, s[60:61], 9600
    s_load_dword s31, s[58:59], 1152
    s_load_dword s31, s[60:61], 9664
    s_load_dword s31, s[58:59], 1216
    s_load_dword s31, s[60:61], 10624
    s_load_dword s31, s[58:59], 1280
    s_load_dword s31, s[60:61], 10688
    s_load_dword s31, s[58:59], 1344
    s_add_u32 m0, s57, 57344
    s_mul_i32 s63, s62, 176128
    s_add_u32 s62, s62, 1
    s_and_b32 s62, s62, 7
    buffer_load_dwordx4 v48, s[36:39], s63 offen offset:0 lds
    buffer_load_dwordx4 v49, s[36:39], s63 offen offset:1024 lds
    buffer_load_dwordx4 v50, s[36:39], s63 offen offset:2048 lds
    s_add_u32 m0, s56, 86016
    s_lshl_b32 s63, s62, 7
    buffer_load_dwordx4 v44, s[32:35], s63 offen offset:0 lds
    buffer_load_dwordx4 v45, s[32:35], s63 offen offset:1024 lds
    buffer_load_dwordx4 v46, s[32:35], s63 offen offset:2048 lds
    buffer_load_dwordx4 v47, s[32:35], s63 offen offset:3072 lds
    s_waitcnt vmcnt(11)
    s_barrier
    s_add_u32 m0, s57, 86016
    s_mul_i32 s63, s62, 176128
    s_add_u32 s62, s62, 1
    s_and_b32 s62, s62, 7
    buffer_load_dwordx4 v48, s[36:39], s63 offen offset:0 lds
    buffer_load_dwordx4 v49, s[36:39], s63 offen offset:1024 lds
    buffer_load_dwordx4 v50, s[36:39], s63 offen offset:2048 lds
    s_add_u32 m0, s26, 114688
    s_add_u32 s66, s27, 0
    s_lshl_b32 s66, s66, 15
    buffer_load_dwordx4 v51, s[48:51], s66 offen offset:0 lds
    buffer_load_dwordx4 v52, s[48:51], s66 offen offset:1024 lds
    buffer_load_dwordx4 v53, s[48:51], s66 offen offset:2048 lds
    buffer_load_dwordx4 v54, s[48:51], s66 offen offset:3072 lds
    s_waitcnt vmcnt(11)
    s_barrier
    s_add_u32 m0, s26, 131072
    s_add_u32 s66, s27, 1
    s_lshl_b32 s66, s66, 15
    buffer_load_dwordx4 v51, s[48:51], s66 offen offset:0 lds
    buffer_load_dwordx4 v52, s[48:51], s66 offen offset:1024 lds
    buffer_load_dwordx4 v53, s[48:51], s66 offen offset:2048 lds
    buffer_load_dwordx4 v54, s[48:51], s66 offen offset:3072 lds
    s_add_u32 m0, s26, 147456
    s_add_u32 s66, s27, 2
    s_lshl_b32 s66, s66, 15
    buffer_load_dwordx4 v51, s[48:51], s66 offen offset:0 lds
    buffer_load_dwordx4 v52, s[48:51], s66 offen offset:1024 lds
    buffer_load_dwordx4 v53, s[48:51], s66 offen offset:2048 lds
    s_waitcnt vmcnt(11)
    s_barrier
    buffer_load_dwordx4 v54, s[48:51], s66 offen offset:3072 lds
    s_add_u32 m0, s26, 0
    s_add_u32 s66, s27, 3
    s_lshl_b32 s66, s66, 15
    buffer_load_dwordx4 v51, s[48:51], s66 offen offset:0 lds
    buffer_load_dwordx4 v52, s[48:51], s66 offen offset:1024 lds
    buffer_load_dwordx4 v53, s[48:51], s66 offen offset:2048 lds
    buffer_load_dwordx4 v54, s[48:51], s66 offen offset:3072 lds
    s_add_u32 m0, s26, 16384
    s_add_u32 s66, s27, 4
    s_lshl_b32 s66, s66, 15
    buffer_load_dwordx4 v51, s[48:51], s66 offen offset:0 lds
    buffer_load_dwordx4 v52, s[48:51], s66 offen offset:1024 lds
    buffer_load_dwordx4 v53, s[48:51], s66 offen offset:2048 lds
    buffer_load_dwordx4 v54, s[48:51], s66 offen offset:3072 lds
    s_mov_b32 s32, s16
    s_mov_b32 s33, s17
    s_mov_b32 s34, 1024
    s_mov_b32 s35, 0x20000
    v_and_b32 v4, 7, v1
    v_lshlrev_b32 v4, 4, v4
    buffer_load_dwordx4 v[32:35], v4, s[32:35], s69 offen
    s_waitcnt lgkmcnt(0)
    buffer_load_dword v24, v25, s[44:47], 0 offen sc1
    s_add_u32 s63, s68, 88064
    s_add_u32 s36, s22, s68
    s_addc_u32 s37, s23, 0
    s_mov_b32 s38, 88064
    s_mov_b32 s39, 0x20000
    s_lshl_b32 s31, s28, 4
    s_mov_b32 s60, 0x00f8000f
    s_mov_b32 s61, 0x78000780
    s_lshr_b64 s[60:61], s[60:61], s31
    s_and_b32 s56, s60, 0xffff
    s_waitcnt vmcnt(0)
    v_lshlrev_b32 v36, 16, v32
    v_and_b32 v37, 0xffff0000, v32
    v_lshlrev_b32 v38, 16, v33
    v_and_b32 v39, 0xffff0000, v33
    v_lshlrev_b32 v40, 16, v34
    v_and_b32 v41, 0xffff0000, v34
    v_lshlrev_b32 v42, 16, v35
    v_and_b32 v43, 0xffff0000, v35
    ds_read_b64_tr_b16 v[240:241], v10 offset:49152
    ds_read_b64_tr_b16 v[242:243], v10 offset:51200
    ds_read_b64_tr_b16 v[244:245], v11 offset:49152
    ds_read_b64_tr_b16 v[246:247], v11 offset:51200
    ds_read_b64_tr_b16 v[248:249], v12 offset:49152
    ds_read_b64_tr_b16 v[250:251], v12 offset:51200
    ds_read_b64_tr_b16 v[252:253], v13 offset:49152
    ds_read_b64_tr_b16 v[254:255], v13 offset:51200
    s_barrier
    s_add_u32 m0, s26, 32768
    s_add_u32 s66, s27, 5
    s_lshl_b32 s66, s66, 15
    buffer_load_dwordx4 v51, s[48:51], s66 offen offset:0 lds
    buffer_load_dwordx4 v52, s[48:51], s66 offen offset:1024 lds
    buffer_load_dwordx4 v53, s[48:51], s66 offen offset:2048 lds
    buffer_load_dwordx4 v54, s[48:51], s66 offen offset:3072 lds
    s_waitcnt vmcnt(4)
    s_add_u32 m0, s26, 49152
    s_add_u32 s66, s27, 6
    s_lshl_b32 s66, s66, 15
    buffer_load_dwordx4 v51, s[48:51], s66 offen offset:0 lds
    buffer_load_dwordx4 v52, s[48:51], s66 offen offset:1024 lds
    buffer_load_dwordx4 v53, s[48:51], s66 offen offset:2048 lds
    buffer_load_dwordx4 v54, s[48:51], s66 offen offset:3072 lds
    s_waitcnt vmcnt(4)
    s_add_u32 m0, s26, 65536
    s_add_u32 s66, s27, 7
    s_lshl_b32 s66, s66, 15
    buffer_load_dwordx4 v51, s[48:51], s66 offen offset:0 lds
    buffer_load_dwordx4 v52, s[48:51], s66 offen offset:1024 lds
    buffer_load_dwordx4 v53, s[48:51], s66 offen offset:2048 lds
    buffer_load_dwordx4 v54, s[48:51], s66 offen offset:3072 lds
    s_waitcnt vmcnt(4)
    s_add_u32 m0, s26, 81920
    s_add_u32 s66, s27, 8
    s_lshl_b32 s66, s66, 15
    buffer_load_dwordx4 v51, s[48:51], s66 offen offset:0 lds
    buffer_load_dwordx4 v52, s[48:51], s66 offen offset:1024 lds
    buffer_load_dwordx4 v53, s[48:51], s66 offen offset:2048 lds
    buffer_load_dwordx4 v54, s[48:51], s66 offen offset:3072 lds
    s_waitcnt vmcnt(4)
    s_add_u32 m0, s26, 98304
    s_add_u32 s66, s27, 9
    s_lshl_b32 s66, s66, 15
    buffer_load_dwordx4 v51, s[48:51], s66 offen offset:0 lds
    buffer_load_dwordx4 v52, s[48:51], s66 offen offset:1024 lds
    buffer_load_dwordx4 v53, s[48:51], s66 offen offset:2048 lds
    buffer_load_dwordx4 v54, s[48:51], s66 offen offset:3072 lds
    buffer_load_dword v27, v26, s[40:43], s63 offen sc1
    s_waitcnt lgkmcnt(0)
    s_barrier
    s_add_u32 m0, s26, 114688
    s_add_u32 s66, s27, 10
    s_lshl_b32 s66, s66, 15
    buffer_load_dwordx4 v51, s[48:51], s66 offen offset:0 lds
    buffer_load_dwordx4 v52, s[48:51], s66 offen offset:1024 lds
    buffer_load_dwordx4 v53, s[48:51], s66 offen offset:2048 lds
    buffer_load_dwordx4 v54, s[48:51], s66 offen offset:3072 lds
    buffer_load_dword v28, v26, s[40:43], s63 offen sc1
    s_waitcnt vmcnt(5)
    s_branch L_PHASE2
L_NOFLAG:
    s_waitcnt vmcnt(0) lgkmcnt(0)
    s_barrier
    ds_read_b64_tr_b16 v[240:241], v10 offset:49152
    ds_read_b64_tr_b16 v[242:243], v10 offset:51200
    ds_read_b64_tr_b16 v[244:245], v11 offset:49152
    ds_read_b64_tr_b16 v[246:247], v11 offset:51200
    ds_read_b64_tr_b16 v[248:249], v12 offset:49152
    ds_read_b64_tr_b16 v[250:251], v12 offset:51200
    ds_read_b64_tr_b16 v[252:253], v13 offset:49152
    ds_read_b64_tr_b16 v[254:255], v13 offset:51200
    v_lshlrev_b32 v36, 16, v32
    v_and_b32 v37, 0xffff0000, v32
    v_lshlrev_b32 v38, 16, v33
    v_and_b32 v39, 0xffff0000, v33
    v_lshlrev_b32 v40, 16, v34
    v_and_b32 v41, 0xffff0000, v34
    v_lshlrev_b32 v42, 16, v35
    v_and_b32 v43, 0xffff0000, v35
    s_branch L_C2
L_PN_RETRY:
    s_cmp_gt_u32 s67, 1048576
    s_cbranch_scc1 L_PN_OK
    s_sleep 16
    buffer_load_dword v24, v25, s[44:47], 0 offen sc1
    s_waitcnt vmcnt(0)
    s_branch L_PN
L_ST14:
    s_barrier
    s_branch L_LASTF
L_CN_RETRY:
    s_cmp_gt_u32 s67, 1048576
    s_cbranch_scc1 L_CN_OK
    s_sleep 16
    buffer_load_dword v24, v25, s[44:47], 0 offen sc1
    s_waitcnt vmcnt(0)
    s_branch L_CN
L_PAD:
.fill 653, 4, 0xbf810000
L_C:
    s_add_u32 s30, s3, 1
    s_and_b32 s30, s30, 3
    s_lshl_b32 s30, s30, 1
    s_lshl_b32 s25, s5, 3
    s_add_u32 s25, s25, s30
    s_lshr_b32 s30, s3, 2
    s_add_u32 s25, s25, s30
    s_lshr_b32 s29, s7, 2
    s_lshl_b32 s26, s28, 12
    s_mul_i32 s27, s28, 11
    v_lshrrev_b32 v3, 2, v1
    v_lshlrev_b32 v3, 7, v3
    v_bfe_u32 v4, v1, 3, 2
    v_lshl_add_u32 v3, v4, 5, v3
    v_and_b32 v4, 3, v1
    v_lshl_add_u32 v3, v4, 3, v3
    v_lshl_add_u32 v6, v2, 12, v3
    v_xor_b32 v7, 32, v6
    v_xor_b32 v8, 64, v6
    v_xor_b32 v9, 0x60, v6
    v_add_u32 v10, 65536, v6
    v_add_u32 v11, 65536, v7
    v_add_u32 v12, 65536, v8
    v_add_u32 v13, 65536, v9
    v_add_u32 v14, 131072, v6
    v_add_u32 v15, 131072, v7
    v_add_u32 v16, 131072, v8
    v_add_u32 v17, 131072, v9
    v_lshlrev_b32 v18, 4, v1
    s_cmp_eq_u32 s29, 0
    s_cselect_b32 s30, 131072, 0
    v_and_b32 v3, 15, v1
    v_lshrrev_b32 v4, 4, v1
    v_and_b32 v5, 7, v1
    v_xor_b32 v4, v4, v5
    v_lshlrev_b32 v4, 4, v4
    v_lshl_add_u32 v4, v3, 8, v4
    v_lshl_add_u32 v4, v2, 13, v4
    v_add_u32 v19, s30, v4
    v_xor_b32 v20, 64, v19
    v_lshrrev_b32 v3, 3, v1
    v_lshlrev_b32 v4, 1, v5
    v_xor_b32 v4, v4, v3
    v_lshlrev_b32 v4, 4, v4
    v_lshl_add_u32 v3, v2, 3, v3
    v_lshl_add_u32 v4, v3, 8, v4
    v_add_u32 v21, s30, v4
    v_xor_b32 v22, 16, v21
    v_lshlrev_b32 v5, 4, v5
    v_lshl_add_u32 v23, v3, 10, v5
    v_and_b32 v3, 31, v1
    v_lshlrev_b32 v25, 2, v3
    v_and_b32 v26, 15, v1
    v_lshlrev_b32 v26, 2, v26
    s_lshl_b32 s30, s25, 1
    s_add_u32 s30, s30, s29
    s_mul_i32 s68, s30, 90112
    s_lshl_b32 s69, s4, 7
    s_lshl_b32 s67, s30, 15
    s_add_u32 s67, s67, s69
    v_mov_b32 v196, 0
    v_mov_b32 v197, 0
    v_mov_b32 v198, 0
    v_mov_b32 v199, 0
    v_mov_b32 v200, 0
    v_mov_b32 v201, 0
    v_mov_b32 v202, 0
    v_mov_b32 v203, 0
    v_mov_b32 v204, 0
    v_mov_b32 v205, 0
    v_mov_b32 v206, 0
    v_mov_b32 v207, 0
    v_mov_b32 v208, 0
    v_mov_b32 v209, 0
    v_mov_b32 v210, 0
    v_mov_b32 v211, 0
    v_mov_b32 v212, 0
    v_mov_b32 v213, 0
    v_mov_b32 v214, 0
    v_mov_b32 v215, 0
    v_mov_b32 v216, 0
    v_mov_b32 v217, 0
    v_mov_b32 v218, 0
    v_mov_b32 v219, 0
    v_and_b32 v3, 15, v1
    v_lshrrev_b32 v5, 4, v1
    v_lshrrev_b32 v4, 1, v3
    v_xor_b32 v4, v4, v5
    v_lshlrev_b32 v4, 4, v4
    v_lshl_add_u32 v4, v3, 7, v4
    v_lshl_add_u32 v44, v2, 12, v4
    v_xor_b32 v45, 64, v44
    v_add_u32 v46, 57344, v44
    v_add_u32 v47, 57344, v45
    v_lshrrev_b32 v4, 2, v3
    v_lshl_add_u32 v4, v5, 3, v4
    v_mul_u32_u24 v4, 192, v4
    v_and_b32 v3, 3, v1
    v_lshl_add_u32 v4, v3, 3, v4
    v_add_u32 v4, 16384, v4
    v_and_b32 v3, 1, v5
    v_lshlrev_b32 v3, 5, v3
    v_add_u32 v48, v4, v3
    v_sub_u32 v49, v4, v3
    v_add_u32 v50, 57344, v48
    v_add_u32 v51, 57344, v49
    v_mov_b32 v194, 0
    v_mov_b32 v195, 0
    v_mov_b32 v3, 0x3f80
    v_cmp_eq_u32 vcc, 0, v5
    s_nop 1
    v_cndmask_b32 v196, 0, v3, vcc
    v_cmp_eq_u32 vcc, 1, v5
    s_nop 1
    v_cndmask_b32 v200, 0, v3, vcc
    v_cmp_eq_u32 vcc, 2, v5
    s_nop 1
    v_cndmask_b32 v204, 0, v3, vcc
    v_cmp_eq_u32 vcc, 3, v5
    s_nop 1
    v_cndmask_b32 v208, 0, v3, vcc
    v_mov_b32 v213, v196
    v_mov_b32 v217, v200
    s_nop 0
    v_mov_b32 v56, 0xc0135761
    v_mov_b32 v57, 0xc0135761
    s_mov_b32 s48, 0xbdd2d3e8
    s_mov_b32 s49, 0xbdd2d3e8
    v_bfe_u32 v3, v1, 4, 1
    v_mul_u32_u24 v3, 90112, v3
    v_add_u32 v3, v3, v26
    v_lshlrev_b32 v5, 1, v1
    v_lshlrev_b32 v52, 24, v1
    s_mul_i32 s58, s24, 192
    s_lshl_b32 s59, s6, 2
    s_add_u32 s59, s59, s7
    s_mul_i32 s62, s59, 90112
    s_mul_i32 s61, s24, 6144
    s_add_u32 s50, s62, s61
    s_add_u32 s51, s50, 4096
    s_lshl_b32 s63, s24, 2
    s_add_u32 s62, s62, s63
    s_add_u32 s66, s62, 88064
    s_mul_i32 s63, s25, 180224
    s_add_u32 s63, s63, 88064
    s_lshr_b32 s59, s59, 1
    s_waitcnt lgkmcnt(0)
    s_mov_b32 s32, s12
    s_mov_b32 s33, s13
    s_mov_b32 s34, 2752
    s_mov_b32 s35, 0x20000
    buffer_load_ushort v192, v5, s[32:35], s58 offen
    buffer_load_ushort v193, v5, s[32:35], s58 offen offset:128
    s_mov_b32 s40, s22
    s_mov_b32 s41, s23
    s_mov_b32 s42, 5767168
    s_mov_b32 s43, 0x20000
    s_mov_b32 s44, s20
    s_mov_b32 s45, s21
    s_mov_b32 s46, 256
    s_mov_b32 s47, 0x20000
    s_add_u32 s52, s18, s67
    s_addc_u32 s53, s19, 0
    s_sub_u32 s54, 2097152, s67
    s_mov_b32 s55, 0x20000
    s_or_b32 s61, s4, s7
    s_cmp_lg_u32 s61, 0
    s_cbranch_scc1 L_NOLEAD
    buffer_load_dword v27, v3, s[40:43], s63 offen sc1
    v_bfe_u32 v4, v1, 4, 1
    v_sub_u32 v4, v1, v4
    v_add_u32 v4, 2, v4
    s_nop 0
L_NOLEAD:
    s_add_u32 s63, s68, 88064
    s_add_u32 s36, s22, s68
    s_addc_u32 s37, s23, 0
    s_mov_b32 s38, 88064
    s_mov_b32 s39, 0x20000
    s_lshl_b32 s31, s28, 4
    s_mov_b32 s60, 0x00f8000f
    s_mov_b32 s61, 0x78000780
    s_lshr_b64 s[60:61], s[60:61], s31
    s_and_b32 s56, s60, 0xffff
    s_mov_b32 s67, 0
    s_barrier
    ds_read_b128 v[108:111], v44 offset:0
    ds_read_b64_tr_b16 v[124:125], v48 offset:0
    ds_read_b64_tr_b16 v[126:127], v48 offset:768
    ds_read_b128 v[112:115], v44 offset:2048
    ds_read_b64_tr_b16 v[128:129], v49 offset:32
    ds_read_b64_tr_b16 v[130:131], v49 offset:800
    ds_read_b64_tr_b16 v[132:133], v48 offset:64
    ds_read_b64_tr_b16 v[134:135], v48 offset:832
    ds_read_b64_tr_b16 v[136:137], v49 offset:96
    ds_read_b64_tr_b16 v[138:139], v49 offset:864
    ds_read_b64_tr_b16 v[140:141], v48 offset:128
    ds_read_b64_tr_b16 v[142:143], v48 offset:896
    ds_read_b64_tr_b16 v[144:145], v49 offset:160
    ds_read_b64_tr_b16 v[146:147], v49 offset:928
    s_waitcnt lgkmcnt(6)
    v_mfma_f32_16x16x32_bf16 v[60:63], v[124:127], v[108:111], 0
    ds_read_b128 v[116:119], v45 offset:0
    ds_read_b64_tr_b16 v[148:149], v48 offset:6144
    v_mfma_f32_16x16x32_bf16 v[68:71], v[124:127], v[112:115], 0
    ds_read_b64_tr_b16 v[150:151], v48 offset:6912
    ds_read_b128 v[120:123], v45 offset:2048
    v_mfma_f32_16x16x32_bf16 v[64:67], v[128:131], v[108:111], 0
    ds_read_b64_tr_b16 v[152:153], v49 offset:6176
    ds_read_b64_tr_b16 v[154:155], v49 offset:6944
    v_mfma_f32_16x16x32_bf16 v[72:75], v[128:131], v[112:115], 0
    ds_read_b64_tr_b16 v[156:157], v48 offset:6208
    v_mfma_f32_16x16x32_bf16 v[76:79], v[132:135], v[108:111], 0
    ds_read_b64_tr_b16 v[158:159], v48 offset:6976
    v_mfma_f32_16x16x32_bf16 v[84:87], v[132:135], v[112:115], 0
    s_waitcnt lgkmcnt(8)
    v_mfma_f32_16x16x32_bf16 v[80:83], v[136:139], v[108:111], 0
    ds_read_b64_tr_b16 v[124:125], v49 offset:6240
    ds_read_b64_tr_b16 v[126:127], v49 offset:7008
    v_mfma_f32_16x16x32_bf16 v[88:91], v[136:139], v[112:115], 0
    ds_read_b64_tr_b16 v[128:129], v48 offset:6272
    v_mfma_f32_16x16x32_bf16 v[92:95], v[140:143], v[108:111], 0
    ds_read_b64_tr_b16 v[130:131], v48 offset:7040
    v_mfma_f32_16x16x32_bf16 v[100:103], v[140:143], v[112:115], 0
    ds_read_b64_tr_b16 v[132:133], v49 offset:6304
    v_mfma_f32_16x16x32_bf16 v[96:99], v[144:147], v[108:111], 0
    ds_read_b64_tr_b16 v[134:135], v49 offset:7072
    v_mfma_f32_16x16x32_bf16 v[104:107], v[144:147], v[112:115], 0
    s_waitcnt lgkmcnt(6)
    v_mfma_f32_16x16x32_bf16 v[60:63], v[148:151], v[116:119], v[60:63]
    v_mfma_f32_16x16x32_bf16 v[68:71], v[148:151], v[120:123], v[68:71]
    v_mfma_f32_16x16x32_bf16 v[64:67], v[152:155], v[116:119], v[64:67]
    v_mfma_f32_16x16x32_bf16 v[72:75], v[152:155], v[120:123], v[72:75]
    v_mfma_f32_16x16x32_bf16 v[76:79], v[156:159], v[116:119], v[76:79]
    v_mfma_f32_16x16x32_bf16 v[84:87], v[156:159], v[120:123], v[84:87]
    s_waitcnt vmcnt(0)
    v_mfma_f32_16x16x32_bf16 v[60:63], v[192:195], v[196:199], v[60:63]
    v_mfma_f32_16x16x32_bf16 v[68:71], v[192:195], v[196:199], v[68:71]
    v_mfma_f32_16x16x32_bf16 v[64:67], v[192:195], v[200:203], v[64:67]
    v_mfma_f32_16x16x32_bf16 v[72:75], v[192:195], v[200:203], v[72:75]
    v_mfma_f32_16x16x32_bf16 v[76:79], v[192:195], v[204:207], v[76:79]
    v_mfma_f32_16x16x32_bf16 v[84:87], v[192:195], v[204:207], v[84:87]
    v_mfma_f32_16x16x32_bf16 v[80:83], v[192:195], v[208:211], v[80:83]
    v_mfma_f32_16x16x32_bf16 v[88:91], v[192:195], v[208:211], v[88:91]
    v_mfma_f32_16x16x32_bf16 v[92:95], v[192:195], v[212:215], v[92:95]
    v_mfma_f32_16x16x32_bf16 v[100:103], v[192:195], v[212:215], v[100:103]
    v_mfma_f32_16x16x32_bf16 v[96:99], v[192:195], v[216:219], v[96:99]
    v_mfma_f32_16x16x32_bf16 v[104:107], v[192:195], v[216:219], v[104:107]
    s_or_b32 s61, s4, s7
    s_cmp_lg_u32 s61, 0
    s_cbranch_scc1 L_NOLEAD2
    v_bfe_u32 v4, v1, 4, 1
    v_sub_u32 v4, v1, v4
    v_add_u32 v4, 2, v4
    v_lshrrev_b32 v4, v4, v27
    v_and_b32 v4, 1, v4
    v_cmp_eq_u32 vcc, 0, v4
    s_lshl_b32 s30, s25, 2
    s_nop 0
    s_and_b32 s31, vcc_lo, 0x7fff
    s_lshl_b32 s31, s31, 2
    s_and_b32 s61, vcc_lo, 0x7fff0000
    s_lshl_b32 s61, s61, 1
    s_or_b32 s31, s31, s61
    s_or_b32 s31, s31, 1
    v_mov_b32 v4, s31
    buffer_store_dword v4, v52, s[44:47], s30 offen sc1
L_NOLEAD2:
    s_waitcnt lgkmcnt(0)
    s_barrier
    ds_read_b128 v[108:111], v44 offset:28672
    ds_read_b64_tr_b16 v[136:137], v48 offset:28672
    ds_read_b64_tr_b16 v[138:139], v48 offset:29440
    ds_read_b128 v[112:115], v44 offset:30720
    ds_read_b64_tr_b16 v[140:141], v49 offset:28704
    ds_read_b64_tr_b16 v[142:143], v49 offset:29472
    ds_read_b64_tr_b16 v[144:145], v48 offset:28736
    ds_read_b64_tr_b16 v[146:147], v48 offset:29504
    v_mfma_f32_16x16x32_bf16 v[80:83], v[124:127], v[116:119], v[80:83]
    ds_read_b64_tr_b16 v[148:149], v49 offset:28768
    ds_read_b64_tr_b16 v[150:151], v49 offset:29536
    v_mfma_f32_16x16x32_bf16 v[88:91], v[124:127], v[120:123], v[88:91]
    ds_read_b64_tr_b16 v[152:153], v48 offset:28800
    v_mfma_f32_16x16x32_bf16 v[92:95], v[128:131], v[116:119], v[92:95]
    ds_read_b64_tr_b16 v[154:155], v48 offset:29568
    v_mfma_f32_16x16x32_bf16 v[100:103], v[128:131], v[120:123], v[100:103]
    ds_read_b64_tr_b16 v[156:157], v49 offset:28832
    v_mfma_f32_16x16x32_bf16 v[96:99], v[132:135], v[116:119], v[96:99]
    ds_read_b64_tr_b16 v[158:159], v49 offset:29600
    v_mfma_f32_16x16x32_bf16 v[104:107], v[132:135], v[120:123], v[104:107]
    s_waitcnt lgkmcnt(6)
    v_mfma_f32_16x16x32_bf16 v[60:63], v[136:139], v[108:111], v[60:63]
    ds_read_b128 v[116:119], v45 offset:28672
    ds_read_b64_tr_b16 v[124:125], v48 offset:34816
    v_mfma_f32_16x16x32_bf16 v[68:71], v[136:139], v[112:115], v[68:71]
    ds_read_b64_tr_b16 v[126:127], v48 offset:35584
    ds_read_b128 v[120:123], v45 offset:30720
    v_mfma_f32_16x16x32_bf16 v[64:67], v[140:143], v[108:111], v[64:67]
    ds_read_b64_tr_b16 v[128:129], v49 offset:34848
    ds_read_b64_tr_b16 v[130:131], v49 offset:35616
    v_mfma_f32_16x16x32_bf16 v[72:75], v[140:143], v[112:115], v[72:75]
    ds_read_b64_tr_b16 v[132:133], v48 offset:34880
    v_mfma_f32_16x16x32_bf16 v[76:79], v[144:147], v[108:111], v[76:79]
    ds_read_b64_tr_b16 v[134:135], v48 offset:35648
    v_mfma_f32_16x16x32_bf16 v[84:87], v[144:147], v[112:115], v[84:87]
    s_waitcnt lgkmcnt(8)
    v_mfma_f32_16x16x32_bf16 v[80:83], v[148:151], v[108:111], v[80:83]
    ds_read_b64_tr_b16 v[136:137], v49 offset:34912
    ds_read_b64_tr_b16 v[138:139], v49 offset:35680
    v_mfma_f32_16x16x32_bf16 v[88:91], v[148:151], v[112:115], v[88:91]
    ds_read_b64_tr_b16 v[140:141], v48 offset:34944
    v_mfma_f32_16x16x32_bf16 v[92:95], v[152:155], v[108:111], v[92:95]
    ds_read_b64_tr_b16 v[142:143], v48 offset:35712
    v_mfma_f32_16x16x32_bf16 v[100:103], v[152:155], v[112:115], v[100:103]
    ds_read_b64_tr_b16 v[144:145], v49 offset:34976
    v_mfma_f32_16x16x32_bf16 v[96:99], v[156:159], v[108:111], v[96:99]
    ds_read_b64_tr_b16 v[146:147], v49 offset:35744
    v_mfma_f32_16x16x32_bf16 v[104:107], v[156:159], v[112:115], v[104:107]
    s_waitcnt lgkmcnt(6)
    v_mfma_f32_16x16x32_bf16 v[60:63], v[124:127], v[116:119], v[60:63]
    v_mfma_f32_16x16x32_bf16 v[68:71], v[124:127], v[120:123], v[68:71]
    v_mfma_f32_16x16x32_bf16 v[64:67], v[128:131], v[116:119], v[64:67]
    v_mfma_f32_16x16x32_bf16 v[72:75], v[128:131], v[120:123], v[72:75]
    v_mfma_f32_16x16x32_bf16 v[76:79], v[132:135], v[116:119], v[76:79]
    v_mfma_f32_16x16x32_bf16 v[84:87], v[132:135], v[120:123], v[84:87]
    s_waitcnt lgkmcnt(0)
    s_barrier
    ds_read_b128 v[108:111], v46 offset:0
    ds_read_b64_tr_b16 v[148:149], v50 offset:0
    ds_read_b64_tr_b16 v[150:151], v50 offset:768
    ds_read_b128 v[112:115], v46 offset:2048
    ds_read_b64_tr_b16 v[152:153], v51 offset:32
    ds_read_b64_tr_b16 v[154:155], v51 offset:800
    ds_read_b64_tr_b16 v[156:157], v50 offset:64
    ds_read_b64_tr_b16 v[158:159], v50 offset:832
    v_mfma_f32_16x16x32_bf16 v[80:83], v[136:139], v[116:119], v[80:83]
    ds_read_b64_tr_b16 v[124:125], v51 offset:96
    ds_read_b64_tr_b16 v[126:127], v51 offset:864
    v_mfma_f32_16x16x32_bf16 v[88:91], v[136:139], v[120:123], v[88:91]
    ds_read_b64_tr_b16 v[128:129], v50 offset:128
    v_mfma_f32_16x16x32_bf16 v[92:95], v[140:143], v[116:119], v[92:95]
    ds_read_b64_tr_b16 v[130:131], v50 offset:896
    v_mfma_f32_16x16x32_bf16 v[100:103], v[140:143], v[120:123], v[100:103]
    ds_read_b64_tr_b16 v[132:133], v51 offset:160
    v_mfma_f32_16x16x32_bf16 v[96:99], v[144:147], v[116:119], v[96:99]
    ds_read_b64_tr_b16 v[134:135], v51 offset:928
    v_mfma_f32_16x16x32_bf16 v[104:107], v[144:147], v[120:123], v[104:107]
    s_waitcnt lgkmcnt(6)
    v_mfma_f32_16x16x32_bf16 v[60:63], v[148:151], v[108:111], v[60:63]
    ds_read_b128 v[116:119], v47 offset:0
    ds_read_b64_tr_b16 v[136:137], v50 offset:6144
    v_mfma_f32_16x16x32_bf16 v[68:71], v[148:151], v[112:115], v[68:71]
    ds_read_b64_tr_b16 v[138:139], v50 offset:6912
    ds_read_b128 v[120:123], v47 offset:2048
    v_mfma_f32_16x16x32_bf16 v[64:67], v[152:155], v[108:111], v[64:67]
    ds_read_b64_tr_b16 v[140:141], v51 offset:6176
    ds_read_b64_tr_b16 v[142:143], v51 offset:6944
    v_mfma_f32_16x16x32_bf16 v[72:75], v[152:155], v[112:115], v[72:75]
    ds_read_b64_tr_b16 v[144:145], v50 offset:6208
    v_mfma_f32_16x16x32_bf16 v[76:79], v[156:159], v[108:111], v[76:79]
    ds_read_b64_tr_b16 v[146:147], v50 offset:6976
    v_mfma_f32_16x16x32_bf16 v[84:87], v[156:159], v[112:115], v[84:87]
    s_waitcnt lgkmcnt(8)
    v_mfma_f32_16x16x32_bf16 v[80:83], v[124:127], v[108:111], v[80:83]
    ds_read_b64_tr_b16 v[148:149], v51 offset:6240
    ds_read_b64_tr_b16 v[150:151], v51 offset:7008
    v_mfma_f32_16x16x32_bf16 v[88:91], v[124:127], v[112:115], v[88:91]
    ds_read_b64_tr_b16 v[152:153], v50 offset:6272
    v_mfma_f32_16x16x32_bf16 v[92:95], v[128:131], v[108:111], v[92:95]
    ds_read_b64_tr_b16 v[154:155], v50 offset:7040
    v_mfma_f32_16x16x32_bf16 v[100:103], v[128:131], v[112:115], v[100:103]
    ds_read_b64_tr_b16 v[156:157], v51 offset:6304
    v_mfma_f32_16x16x32_bf16 v[96:99], v[132:135], v[108:111], v[96:99]
    ds_read_b64_tr_b16 v[158:159], v51 offset:7072
    v_mfma_f32_16x16x32_bf16 v[104:107], v[132:135], v[112:115], v[104:107]
    s_waitcnt lgkmcnt(6)
    v_mfma_f32_16x16x32_bf16 v[60:63], v[136:139], v[116:119], v[60:63]
    v_mfma_f32_16x16x32_bf16 v[68:71], v[136:139], v[120:123], v[68:71]
    v_mfma_f32_16x16x32_bf16 v[64:67], v[140:143], v[116:119], v[64:67]
    v_mfma_f32_16x16x32_bf16 v[72:75], v[140:143], v[120:123], v[72:75]
    v_mfma_f32_16x16x32_bf16 v[76:79], v[144:147], v[116:119], v[76:79]
    v_mfma_f32_16x16x32_bf16 v[84:87], v[144:147], v[120:123], v[84:87]
    s_waitcnt lgkmcnt(0)
    s_barrier
    ds_read_b128 v[108:111], v46 offset:28672
    ds_read_b64_tr_b16 v[124:125], v50 offset:28672
    ds_read_b64_tr_b16 v[126:127], v50 offset:29440
    ds_read_b128 v[112:115], v46 offset:30720
    ds_read_b64_tr_b16 v[128:129], v51 offset:28704
    ds_read_b64_tr_b16 v[130:131], v51 offset:29472
    ds_read_b64_tr_b16 v[132:133], v50 offset:28736
    ds_read_b64_tr_b16 v[134:135], v50 offset:29504
    v_mfma_f32_16x16x32_bf16 v[80:83], v[148:151], v[116:119], v[80:83]
    ds_read_b64_tr_b16 v[136:137], v51 offset:28768
    ds_read_b64_tr_b16 v[138:139], v51 offset:29536
    v_mfma_f32_16x16x32_bf16 v[88:91], v[148:151], v[120:123], v[88:91]
    ds_read_b64_tr_b16 v[140:141], v50 offset:28800
    v_mfma_f32_16x16x32_bf16 v[92:95], v[152:155], v[116:119], v[92:95]
    ds_read_b64_tr_b16 v[142:143], v50 offset:29568
    v_mfma_f32_16x16x32_bf16 v[100:103], v[152:155], v[120:123], v[100:103]
    ds_read_b64_tr_b16 v[144:145], v51 offset:28832
    v_mfma_f32_16x16x32_bf16 v[96:99], v[156:159], v[116:119], v[96:99]
    ds_read_b64_tr_b16 v[146:147], v51 offset:29600
    v_mfma_f32_16x16x32_bf16 v[104:107], v[156:159], v[120:123], v[104:107]
    s_waitcnt lgkmcnt(6)
    v_mfma_f32_16x16x32_bf16 v[60:63], v[124:127], v[108:111], v[60:63]
    ds_read_b128 v[116:119], v47 offset:28672
    ds_read_b64_tr_b16 v[148:149], v50 offset:34816
    v_mfma_f32_16x16x32_bf16 v[68:71], v[124:127], v[112:115], v[68:71]
    ds_read_b64_tr_b16 v[150:151], v50 offset:35584
    ds_read_b128 v[120:123], v47 offset:30720
    v_mfma_f32_16x16x32_bf16 v[64:67], v[128:131], v[108:111], v[64:67]
    ds_read_b64_tr_b16 v[152:153], v51 offset:34848
    ds_read_b64_tr_b16 v[154:155], v51 offset:35616
    v_mfma_f32_16x16x32_bf16 v[72:75], v[128:131], v[112:115], v[72:75]
    ds_read_b64_tr_b16 v[156:157], v50 offset:34880
    v_mfma_f32_16x16x32_bf16 v[76:79], v[132:135], v[108:111], v[76:79]
    ds_read_b64_tr_b16 v[158:159], v50 offset:35648
    v_mfma_f32_16x16x32_bf16 v[84:87], v[132:135], v[112:115], v[84:87]
    s_waitcnt lgkmcnt(8)
    v_mfma_f32_16x16x32_bf16 v[80:83], v[136:139], v[108:111], v[80:83]
    ds_read_b64_tr_b16 v[124:125], v51 offset:34912
    ds_read_b64_tr_b16 v[126:127], v51 offset:35680
    v_mfma_f32_16x16x32_bf16 v[88:91], v[136:139], v[112:115], v[88:91]
    ds_read_b64_tr_b16 v[128:129], v50 offset:34944
    v_mfma_f32_16x16x32_bf16 v[92:95], v[140:143], v[108:111], v[92:95]
    ds_read_b64_tr_b16 v[130:131], v50 offset:35712
    v_mfma_f32_16x16x32_bf16 v[100:103], v[140:143], v[112:115], v[100:103]
    ds_read_b64_tr_b16 v[132:133], v51 offset:34976
    v_mfma_f32_16x16x32_bf16 v[96:99], v[144:147], v[108:111], v[96:99]
    ds_read_b64_tr_b16 v[134:135], v51 offset:35744
    v_mfma_f32_16x16x32_bf16 v[104:107], v[144:147], v[112:115], v[104:107]
    s_waitcnt lgkmcnt(6)
    v_mfma_f32_16x16x32_bf16 v[60:63], v[148:151], v[116:119], v[60:63]
    v_mfma_f32_16x16x32_bf16 v[68:71], v[148:151], v[120:123], v[68:71]
    v_mfma_f32_16x16x32_bf16 v[64:67], v[152:155], v[116:119], v[64:67]
    v_mfma_f32_16x16x32_bf16 v[72:75], v[152:155], v[120:123], v[72:75]
    v_mfma_f32_16x16x32_bf16 v[76:79], v[156:159], v[116:119], v[76:79]
    v_mfma_f32_16x16x32_bf16 v[84:87], v[156:159], v[120:123], v[84:87]
    s_waitcnt lgkmcnt(0)
    s_barrier
    ds_read_b128 v[108:111], v44 offset:0
    ds_read_b64_tr_b16 v[136:137], v48 offset:0
    ds_read_b64_tr_b16 v[138:139], v48 offset:768
    ds_read_b128 v[112:115], v44 offset:2048
    ds_read_b64_tr_b16 v[140:141], v49 offset:32
    ds_read_b64_tr_b16 v[142:143], v49 offset:800
    ds_read_b64_tr_b16 v[144:145], v48 offset:64
    ds_read_b64_tr_b16 v[146:147], v48 offset:832
    v_mfma_f32_16x16x32_bf16 v[80:83], v[124:127], v[116:119], v[80:83]
    ds_read_b64_tr_b16 v[148:149], v49 offset:96
    ds_read_b64_tr_b16 v[150:151], v49 offset:864
    v_mfma_f32_16x16x32_bf16 v[88:91], v[124:127], v[120:123], v[88:91]
    ds_read_b64_tr_b16 v[152:153], v48 offset:128
    v_mfma_f32_16x16x32_bf16 v[92:95], v[128:131], v[116:119], v[92:95]
    ds_read_b64_tr_b16 v[154:155], v48 offset:896
    v_mfma_f32_16x16x32_bf16 v[100:103], v[128:131], v[120:123], v[100:103]
    ds_read_b64_tr_b16 v[156:157], v49 offset:160
    v_mfma_f32_16x16x32_bf16 v[96:99], v[132:135], v[116:119], v[96:99]
    ds_read_b64_tr_b16 v[158:159], v49 offset:928
    v_mfma_f32_16x16x32_bf16 v[104:107], v[132:135], v[120:123], v[104:107]
    s_waitcnt lgkmcnt(6)
    v_mfma_f32_16x16x32_bf16 v[60:63], v[136:139], v[108:111], v[60:63]
    ds_read_b128 v[116:119], v45 offset:0
    ds_read_b64_tr_b16 v[124:125], v48 offset:6144
    v_mfma_f32_16x16x32_bf16 v[68:71], v[136:139], v[112:115], v[68:71]
    ds_read_b64_tr_b16 v[126:127], v48 offset:6912
    ds_read_b128 v[120:123], v45 offset:2048
    v_mfma_f32_16x16x32_bf16 v[64:67], v[140:143], v[108:111], v[64:67]
    ds_read_b64_tr_b16 v[128:129], v49 offset:6176
    ds_read_b64_tr_b16 v[130:131], v49 offset:6944
    v_mfma_f32_16x16x32_bf16 v[72:75], v[140:143], v[112:115], v[72:75]
    ds_read_b64_tr_b16 v[132:133], v48 offset:6208
    v_mfma_f32_16x16x32_bf16 v[76:79], v[144:147], v[108:111], v[76:79]
    ds_read_b64_tr_b16 v[134:135], v48 offset:6976
    v_mfma_f32_16x16x32_bf16 v[84:87], v[144:147], v[112:115], v[84:87]
    s_waitcnt lgkmcnt(8)
    v_mfma_f32_16x16x32_bf16 v[80:83], v[148:151], v[108:111], v[80:83]
    ds_read_b64_tr_b16 v[136:137], v49 offset:6240
    ds_read_b64_tr_b16 v[138:139], v49 offset:7008
    v_mfma_f32_16x16x32_bf16 v[88:91], v[148:151], v[112:115], v[88:91]
    ds_read_b64_tr_b16 v[140:141], v48 offset:6272
    v_mfma_f32_16x16x32_bf16 v[92:95], v[152:155], v[108:111], v[92:95]
    ds_read_b64_tr_b16 v[142:143], v48 offset:7040
    v_mfma_f32_16x16x32_bf16 v[100:103], v[152:155], v[112:115], v[100:103]
    ds_read_b64_tr_b16 v[144:145], v49 offset:6304
    v_mfma_f32_16x16x32_bf16 v[96:99], v[156:159], v[108:111], v[96:99]
    ds_read_b64_tr_b16 v[146:147], v49 offset:7072
    v_mfma_f32_16x16x32_bf16 v[104:107], v[156:159], v[112:115], v[104:107]
    s_waitcnt lgkmcnt(6)
    v_mfma_f32_16x16x32_bf16 v[60:63], v[124:127], v[116:119], v[60:63]
    v_mfma_f32_16x16x32_bf16 v[68:71], v[124:127], v[120:123], v[68:71]
    v_mfma_f32_16x16x32_bf16 v[64:67], v[128:131], v[116:119], v[64:67]
    v_mfma_f32_16x16x32_bf16 v[72:75], v[128:131], v[120:123], v[72:75]
    v_mfma_f32_16x16x32_bf16 v[76:79], v[132:135], v[116:119], v[76:79]
    v_mfma_f32_16x16x32_bf16 v[84:87], v[132:135], v[120:123], v[84:87]
    s_waitcnt lgkmcnt(0)
    s_barrier
    buffer_load_dword v24, v25, s[44:47], 0 offen sc1
    s_mov_b32 s32, s16
    s_mov_b32 s33, s17
    s_mov_b32 s34, 1024
    s_mov_b32 s35, 0x20000
    v_and_b32 v4, 7, v1
    v_lshlrev_b32 v4, 4, v4
    buffer_load_dwordx4 v[32:35], v4, s[32:35], s69 offen
    ds_read_b128 v[108:111], v44 offset:28672
    ds_read_b64_tr_b16 v[148:149], v48 offset:28672
    ds_read_b64_tr_b16 v[150:151], v48 offset:29440
    ds_read_b128 v[112:115], v44 offset:30720
    ds_read_b64_tr_b16 v[152:153], v49 offset:28704
    ds_read_b64_tr_b16 v[154:155], v49 offset:29472
    ds_read_b64_tr_b16 v[156:157], v48 offset:28736
    ds_read_b64_tr_b16 v[158:159], v48 offset:29504
    v_mfma_f32_16x16x32_bf16 v[80:83], v[136:139], v[116:119], v[80:83]
    ds_read_b64_tr_b16 v[124:125], v49 offset:28768
    ds_read_b64_tr_b16 v[126:127], v49 offset:29536
    v_mfma_f32_16x16x32_bf16 v[88:91], v[136:139], v[120:123], v[88:91]
    ds_read_b64_tr_b16 v[128:129], v48 offset:28800
    v_mfma_f32_16x16x32_bf16 v[92:95], v[140:143], v[116:119], v[92:95]
    ds_read_b64_tr_b16 v[130:131], v48 offset:29568
    v_mfma_f32_16x16x32_bf16 v[100:103], v[140:143], v[120:123], v[100:103]
    ds_read_b64_tr_b16 v[132:133], v49 offset:28832
    v_mfma_f32_16x16x32_bf16 v[96:99], v[144:147], v[116:119], v[96:99]
    ds_read_b64_tr_b16 v[134:135], v49 offset:29600
    v_mfma_f32_16x16x32_bf16 v[104:107], v[144:147], v[120:123], v[104:107]
    s_waitcnt lgkmcnt(6)
    v_mfma_f32_16x16x32_bf16 v[60:63], v[148:151], v[108:111], v[60:63]
    ds_read_b128 v[116:119], v45 offset:28672
    ds_read_b64_tr_b16 v[136:137], v48 offset:34816
    v_mfma_f32_16x16x32_bf16 v[68:71], v[148:151], v[112:115], v[68:71]
    ds_read_b64_tr_b16 v[138:139], v48 offset:35584
    ds_read_b128 v[120:123], v45 offset:30720
    v_mfma_f32_16x16x32_bf16 v[64:67], v[152:155], v[108:111], v[64:67]
    ds_read_b64_tr_b16 v[140:141], v49 offset:34848
    ds_read_b64_tr_b16 v[142:143], v49 offset:35616
    v_mfma_f32_16x16x32_bf16 v[72:75], v[152:155], v[112:115], v[72:75]
    ds_read_b64_tr_b16 v[144:145], v48 offset:34880
    v_mfma_f32_16x16x32_bf16 v[76:79], v[156:159], v[108:111], v[76:79]
    ds_read_b64_tr_b16 v[146:147], v48 offset:35648
    v_mfma_f32_16x16x32_bf16 v[84:87], v[156:159], v[112:115], v[84:87]
    s_waitcnt lgkmcnt(8)
    v_mfma_f32_16x16x32_bf16 v[80:83], v[124:127], v[108:111], v[80:83]
    ds_read_b64_tr_b16 v[148:149], v49 offset:34912
    ds_read_b64_tr_b16 v[150:151], v49 offset:35680
    v_mfma_f32_16x16x32_bf16 v[88:91], v[124:127], v[112:115], v[88:91]
    ds_read_b64_tr_b16 v[152:153], v48 offset:34944
    v_mfma_f32_16x16x32_bf16 v[92:95], v[128:131], v[108:111], v[92:95]
    ds_read_b64_tr_b16 v[154:155], v48 offset:35712
    v_mfma_f32_16x16x32_bf16 v[100:103], v[128:131], v[112:115], v[100:103]
    ds_read_b64_tr_b16 v[156:157], v49 offset:34976
    v_mfma_f32_16x16x32_bf16 v[96:99], v[132:135], v[108:111], v[96:99]
    ds_read_b64_tr_b16 v[158:159], v49 offset:35744
    v_mfma_f32_16x16x32_bf16 v[104:107], v[132:135], v[112:115], v[104:107]
    s_waitcnt lgkmcnt(6)
    v_mfma_f32_16x16x32_bf16 v[60:63], v[136:139], v[116:119], v[60:63]
    v_mfma_f32_16x16x32_bf16 v[68:71], v[136:139], v[120:123], v[68:71]
    v_mfma_f32_16x16x32_bf16 v[64:67], v[140:143], v[116:119], v[64:67]
    v_mfma_f32_16x16x32_bf16 v[72:75], v[140:143], v[120:123], v[72:75]
    v_mfma_f32_16x16x32_bf16 v[76:79], v[144:147], v[116:119], v[76:79]
    v_mfma_f32_16x16x32_bf16 v[84:87], v[144:147], v[120:123], v[84:87]
    s_waitcnt lgkmcnt(0)
    s_barrier
    ds_read_b128 v[108:111], v46 offset:0
    ds_read_b64_tr_b16 v[124:125], v50 offset:0
    ds_read_b64_tr_b16 v[126:127], v50 offset:768
    ds_read_b128 v[112:115], v46 offset:2048
    ds_read_b64_tr_b16 v[128:129], v51 offset:32
    ds_read_b64_tr_b16 v[130:131], v51 offset:800
    ds_read_b64_tr_b16 v[132:133], v50 offset:64
    ds_read_b64_tr_b16 v[134:135], v50 offset:832
    v_mfma_f32_16x16x32_bf16 v[80:83], v[148:151], v[116:119], v[80:83]
    ds_read_b64_tr_b16 v[136:137], v51 offset:96
    ds_read_b64_tr_b16 v[138:139], v51 offset:864
    v_mfma_f32_16x16x32_bf16 v[88:91], v[148:151], v[120:123], v[88:91]
    ds_read_b64_tr_b16 v[140:141], v50 offset:128
    v_mfma_f32_16x16x32_bf16 v[92:95], v[152:155], v[116:119], v[92:95]
    ds_read_b64_tr_b16 v[142:143], v50 offset:896
    v_mfma_f32_16x16x32_bf16 v[100:103], v[152:155], v[120:123], v[100:103]
    ds_read_b64_tr_b16 v[144:145], v51 offset:160
    v_mfma_f32_16x16x32_bf16 v[96:99], v[156:159], v[116:119], v[96:99]
    ds_read_b64_tr_b16 v[146:147], v51 offset:928
    v_mfma_f32_16x16x32_bf16 v[104:107], v[156:159], v[120:123], v[104:107]
    s_waitcnt lgkmcnt(6)
    v_mfma_f32_16x16x32_bf16 v[60:63], v[124:127], v[108:111], v[60:63]
    ds_read_b128 v[116:119], v47 offset:0
    ds_read_b64_tr_b16 v[148:149], v50 offset:6144
    v_mfma_f32_16x16x32_bf16 v[68:71], v[124:127], v[112:115], v[68:71]
    ds_read_b64_tr_b16 v[150:151], v50 offset:6912
    ds_read_b128 v[120:123], v47 offset:2048
    v_mfma_f32_16x16x32_bf16 v[64:67], v[128:131], v[108:111], v[64:67]
    ds_read_b64_tr_b16 v[152:153], v51 offset:6176
    ds_read_b64_tr_b16 v[154:155], v51 offset:6944
    v_mfma_f32_16x16x32_bf16 v[72:75], v[128:131], v[112:115], v[72:75]
    ds_read_b64_tr_b16 v[156:157], v50 offset:6208
    v_mfma_f32_16x16x32_bf16 v[76:79], v[132:135], v[108:111], v[76:79]
    ds_read_b64_tr_b16 v[158:159], v50 offset:6976
    v_mfma_f32_16x16x32_bf16 v[84:87], v[132:135], v[112:115], v[84:87]
    s_waitcnt lgkmcnt(8)
    v_mfma_f32_16x16x32_bf16 v[80:83], v[136:139], v[108:111], v[80:83]
    ds_read_b64_tr_b16 v[124:125], v51 offset:6240
    ds_read_b64_tr_b16 v[126:127], v51 offset:7008
    v_mfma_f32_16x16x32_bf16 v[88:91], v[136:139], v[112:115], v[88:91]
    ds_read_b64_tr_b16 v[128:129], v50 offset:6272
    v_mfma_f32_16x16x32_bf16 v[92:95], v[140:143], v[108:111], v[92:95]
    ds_read_b64_tr_b16 v[130:131], v50 offset:7040
    v_mfma_f32_16x16x32_bf16 v[100:103], v[140:143], v[112:115], v[100:103]
    ds_read_b64_tr_b16 v[132:133], v51 offset:6304
    v_mfma_f32_16x16x32_bf16 v[96:99], v[144:147], v[108:111], v[96:99]
    ds_read_b64_tr_b16 v[134:135], v51 offset:7072
    v_mfma_f32_16x16x32_bf16 v[104:107], v[144:147], v[112:115], v[104:107]
    s_waitcnt lgkmcnt(6)
    v_mfma_f32_16x16x32_bf16 v[60:63], v[148:151], v[116:119], v[60:63]
    v_mfma_f32_16x16x32_bf16 v[68:71], v[148:151], v[120:123], v[68:71]
    v_mfma_f32_16x16x32_bf16 v[64:67], v[152:155], v[116:119], v[64:67]
    v_mfma_f32_16x16x32_bf16 v[72:75], v[152:155], v[120:123], v[72:75]
    v_mfma_f32_16x16x32_bf16 v[76:79], v[156:159], v[116:119], v[76:79]
    v_mfma_f32_16x16x32_bf16 v[84:87], v[156:159], v[120:123], v[84:87]
    s_waitcnt lgkmcnt(0)
    v_mfma_f32_16x16x32_bf16 v[80:83], v[124:127], v[116:119], v[80:83]
    v_mfma_f32_16x16x32_bf16 v[88:91], v[124:127], v[120:123], v[88:91]
    v_mfma_f32_16x16x32_bf16 v[92:95], v[128:131], v[116:119], v[92:95]
    v_mfma_f32_16x16x32_bf16 v[100:103], v[128:131], v[120:123], v[100:103]
    v_mfma_f32_16x16x32_bf16 v[96:99], v[132:135], v[116:119], v[96:99]
    v_mfma_f32_16x16x32_bf16 v[104:107], v[132:135], v[120:123], v[104:107]
    s_barrier
    ds_read_b128 v[192:195], v46 offset:28672
    ds_read_b64_tr_b16 v[208:209], v50 offset:28672
    ds_read_b64_tr_b16 v[210:211], v50 offset:29440
    ds_read_b64_tr_b16 v[216:217], v51 offset:28704
    ds_read_b64_tr_b16 v[218:219], v51 offset:29472
    ds_read_b128 v[200:203], v47 offset:28672
    ds_read_b64_tr_b16 v[212:213], v50 offset:34816
    ds_read_b64_tr_b16 v[214:215], v50 offset:35584
    ds_read_b64_tr_b16 v[220:221], v51 offset:34848
    ds_read_b64_tr_b16 v[222:223], v51 offset:35616
    ds_read_b128 v[196:199], v46 offset:30720
    ds_read_b128 v[204:207], v47 offset:30720
    s_waitcnt lgkmcnt(7)
    v_mfma_f32_16x16x32_bf16 v[60:63], v[208:211], v[192:195], v[60:63]
    v_mfma_f32_16x16x32_bf16 v[64:67], v[216:219], v[192:195], v[64:67]
    ds_read_b64_tr_b16 v[224:225], v50 offset:28736
    ds_read_b64_tr_b16 v[226:227], v50 offset:29504
    ds_read_b64_tr_b16 v[232:233], v51 offset:28768
    ds_read_b64_tr_b16 v[234:235], v51 offset:29536
    s_waitcnt lgkmcnt(6)
    v_mfma_f32_16x16x32_bf16 v[60:63], v[212:215], v[200:203], v[60:63]
    v_mfma_f32_16x16x32_bf16 v[64:67], v[220:223], v[200:203], v[64:67]
    ds_read_b64_tr_b16 v[228:229], v50 offset:34880
    ds_read_b64_tr_b16 v[230:231], v50 offset:35648
    ds_read_b64_tr_b16 v[236:237], v51 offset:34912
    ds_read_b64_tr_b16 v[238:239], v51 offset:35680
    s_waitcnt lgkmcnt(8)
    v_mfma_f32_16x16x32_bf16 v[68:71], v[208:211], v[196:199], v[68:71]
    ds_read_b64_tr_b16 v[240:241], v50 offset:28800
    ds_read_b64_tr_b16 v[242:243], v50 offset:29568
    v_mfma_f32_16x16x32_bf16 v[72:75], v[216:219], v[196:199], v[72:75]
    ds_read_b64_tr_b16 v[248:249], v51 offset:28832
    ds_read_b64_tr_b16 v[250:251], v51 offset:29600
    v_mfma_f32_16x16x32_bf16 v[68:71], v[212:215], v[204:207], v[68:71]
    v_mfma_f32_16x16x32_bf16 v[72:75], v[220:223], v[204:207], v[72:75]
    s_waitcnt lgkmcnt(8)
    ds_read_b64_tr_b16 v[244:245], v50 offset:34944
    ds_read_b64_tr_b16 v[246:247], v50 offset:35712
    ds_read_b64_tr_b16 v[252:253], v51 offset:34976
    ds_read_b64_tr_b16 v[254:255], v51 offset:35744
    s_cmp_eq_u32 s24, 15
    s_cbranch_scc1 L_NOFLAG
    v_mul_f32 v160, v60, v60
    v_mul_f32 v161, v61, v61
    v_mul_f32 v162, v62, v62
    v_mfma_f32_16x16x32_bf16 v[76:79], v[224:227], v[192:195], v[76:79]
    v_mul_f32 v163, v63, v63
    v_mul_f32 v164, v64, v64
    v_mul_f32 v165, v65, v65
    v_mfma_f32_16x16x32_bf16 v[80:83], v[232:235], v[192:195], v[80:83]
    v_mul_f32 v166, v66, v66
    v_mul_f32 v167, v67, v67
    v_fma_f32 v160, v160, s48, v56
    v_mfma_f32_16x16x32_bf16 v[84:87], v[224:227], v[196:199], v[84:87]
    v_fma_f32 v161, v161, s48, v56
    v_fma_f32 v162, v162, s48, v56
    v_fma_f32 v163, v163, s48, v56
    v_mfma_f32_16x16x32_bf16 v[88:91], v[232:235], v[196:199], v[88:91]
    v_fma_f32 v164, v164, s48, v56
    v_fma_f32 v165, v165, s48, v56
    v_fma_f32 v166, v166, s48, v56
    s_waitcnt lgkmcnt(0)
    v_mfma_f32_16x16x32_bf16 v[76:79], v[228:231], v[200:203], v[76:79]
    v_fma_f32 v167, v167, s48, v56
    v_mul_f32 v160, v160, v60
    v_mul_f32 v161, v161, v61
    v_mfma_f32_16x16x32_bf16 v[80:83], v[236:239], v[200:203], v[80:83]
    v_mul_f32 v162, v162, v62
    v_mul_f32 v163, v163, v63
    v_mul_f32 v164, v164, v64
    v_mfma_f32_16x16x32_bf16 v[84:87], v[228:231], v[204:207], v[84:87]
    v_mul_f32 v165, v165, v65
    v_mul_f32 v166, v166, v66
    v_mul_f32 v167, v167, v67
    v_mfma_f32_16x16x32_bf16 v[88:91], v[236:239], v[204:207], v[88:91]
    v_exp_f32 v160, v160
    v_exp_f32 v161, v161
    v_mfma_f32_16x16x32_bf16 v[92:95], v[240:243], v[192:195], v[92:95]
    v_exp_f32 v162, v162
    v_exp_f32 v163, v163
    v_mfma_f32_16x16x32_bf16 v[96:99], v[248:251], v[192:195], v[96:99]
    v_exp_f32 v164, v164
    v_exp_f32 v165, v165
    v_mfma_f32_16x16x32_bf16 v[100:103], v[240:243], v[196:199], v[100:103]
    v_exp_f32 v166, v166
    v_exp_f32 v167, v167
    v_mfma_f32_16x16x32_bf16 v[104:107], v[248:251], v[196:199], v[104:107]
    v_add_f32 v160, 1.0, v160
    v_add_f32 v161, 1.0, v161
    v_add_f32 v162, 1.0, v162
    v_mfma_f32_16x16x32_bf16 v[92:95], v[244:247], v[200:203], v[92:95]
    v_add_f32 v163, 1.0, v163
    v_add_f32 v164, 1.0, v164
    v_add_f32 v165, 1.0, v165
    v_mfma_f32_16x16x32_bf16 v[96:99], v[252:255], v[200:203], v[96:99]
    v_add_f32 v166, 1.0, v166
    v_add_f32 v167, 1.0, v167
    v_rcp_f32 v160, v160
    v_mfma_f32_16x16x32_bf16 v[100:103], v[244:247], v[204:207], v[100:103]
    v_rcp_f32 v161, v161
    v_rcp_f32 v162, v162
    v_mfma_f32_16x16x32_bf16 v[104:107], v[252:255], v[204:207], v[104:107]
    v_rcp_f32 v163, v163
    v_rcp_f32 v164, v164
    v_rcp_f32 v165, v165
    v_rcp_f32 v166, v166
    v_rcp_f32 v167, v167
    v_mul_f32 v160, v160, v60
    v_mul_f32 v161, v161, v61
    v_mul_f32 v162, v162, v62
    v_mul_f32 v163, v163, v63
    v_mul_f32 v164, v164, v64
    v_mul_f32 v165, v165, v65
    v_mul_f32 v166, v166, v66
    v_mul_f32 v167, v167, v67
    v_cvt_pk_bf16_f32 v168, v160, v161
    v_cvt_pk_bf16_f32 v169, v162, v163
    v_cvt_pk_bf16_f32 v170, v164, v165
    v_cvt_pk_bf16_f32 v171, v166, v167
    buffer_store_dwordx4 v[168:171], v18, s[40:43], s50 offen offset:0 sc1
    v_pk_mul_f32 v[160:161], v[68:69], v[68:69]
    v_pk_mul_f32 v[162:163], v[70:71], v[70:71]
    v_pk_mul_f32 v[164:165], v[72:73], v[72:73]
    v_pk_mul_f32 v[166:167], v[74:75], v[74:75]
    v_pk_fma_f32 v[160:161], v[160:161], s[48:49], v[56:57]
    v_pk_fma_f32 v[162:163], v[162:163], s[48:49], v[56:57]
    v_pk_fma_f32 v[164:165], v[164:165], s[48:49], v[56:57]
    v_pk_fma_f32 v[166:167], v[166:167], s[48:49], v[56:57]
    v_pk_mul_f32 v[160:161], v[160:161], v[68:69]
    v_pk_mul_f32 v[162:163], v[162:163], v[70:71]
    v_pk_mul_f32 v[164:165], v[164:165], v[72:73]
    v_pk_mul_f32 v[166:167], v[166:167], v[74:75]
    v_exp_f32 v160, v160
    v_exp_f32 v161, v161
    v_exp_f32 v162, v162
    v_exp_f32 v163, v163
    v_exp_f32 v164, v164
    v_exp_f32 v165, v165
    v_exp_f32 v166, v166
    v_exp_f32 v167, v167
    v_pk_add_f32 v[160:161], v[160:161], 1.0 op_sel_hi:[1,0]
    v_pk_add_f32 v[162:163], v[162:163], 1.0 op_sel_hi:[1,0]
    v_pk_add_f32 v[164:165], v[164:165], 1.0 op_sel_hi:[1,0]
    v_pk_add_f32 v[166:167], v[166:167], 1.0 op_sel_hi:[1,0]
    v_rcp_f32 v160, v160
    v_rcp_f32 v161, v161
    v_rcp_f32 v162, v162
    v_rcp_f32 v163, v163
    v_rcp_f32 v164, v164
    v_rcp_f32 v165, v165
    v_rcp_f32 v166, v166
    v_rcp_f32 v167, v167
    v_pk_mul_f32 v[160:161], v[160:161], v[68:69]
    v_pk_mul_f32 v[162:163], v[162:163], v[70:71]
    v_pk_mul_f32 v[164:165], v[164:165], v[72:73]
    v_pk_mul_f32 v[166:167], v[166:167], v[74:75]
    v_cvt_pk_bf16_f32 v172, v160, v161
    v_cvt_pk_bf16_f32 v173, v162, v163
    v_cvt_pk_bf16_f32 v174, v164, v165
    v_cvt_pk_bf16_f32 v175, v166, v167
    buffer_store_dwordx4 v[172:175], v18, s[40:43], s50 offen offset:1024 sc1
    s_waitcnt vmcnt(2)
L_PN:
    v_readlane_b32 s31, v24, s59
    s_add_u32 s67, s67, 1
    s_nop 1
    s_cmp_eq_u32 s31, 0
    s_cbranch_scc1 L_PN_RETRY
L_PN_OK:
    v_mov_b32 v53, s31
    v_add_u32 v54, 1, v53
    v_add_u32 v55, 2, v53
    s_cmp_eq_u32 s24, 14
    s_cbranch_scc1 L_ST14
    v_pk_mul_f32 v[160:161], v[76:77], v[76:77]
    v_pk_mul_f32 v[162:163], v[78:79], v[78:79]
    v_pk_mul_f32 v[164:165], v[80:81], v[80:81]
    v_pk_mul_f32 v[166:167], v[82:83], v[82:83]
    v_pk_fma_f32 v[160:161], v[160:161], s[48:49], v[56:57]
    v_pk_fma_f32 v[162:163], v[162:163], s[48:49], v[56:57]
    v_pk_fma_f32 v[164:165], v[164:165], s[48:49], v[56:57]
    v_pk_fma_f32 v[166:167], v[166:167], s[48:49], v[56:57]
    v_pk_mul_f32 v[160:161], v[160:161], v[76:77]
    v_pk_mul_f32 v[162:163], v[162:163], v[78:79]
    v_pk_mul_f32 v[164:165], v[164:165], v[80:81]
    v_pk_mul_f32 v[166:167], v[166:167], v[82:83]
    v_exp_f32 v160, v160
    v_exp_f32 v161, v161
    v_exp_f32 v162, v162
    v_exp_f32 v163, v163
    v_exp_f32 v164, v164
    v_exp_f32 v165, v165
    v_exp_f32 v166, v166
    v_exp_f32 v167, v167
    v_pk_add_f32 v[160:161], v[160:161], 1.0 op_sel_hi:[1,0]
    v_pk_add_f32 v[162:163], v[162:163], 1.0 op_sel_hi:[1,0]
    v_pk_add_f32 v[164:165], v[164:165], 1.0 op_sel_hi:[1,0]
    v_pk_add_f32 v[166:167], v[166:167], 1.0 op_sel_hi:[1,0]
    v_rcp_f32 v160, v160
    v_rcp_f32 v161, v161
    v_rcp_f32 v162, v162
    v_rcp_f32 v163, v163
    v_rcp_f32 v164, v164
    v_rcp_f32 v165, v165
    v_rcp_f32 v166, v166
    v_rcp_f32 v167, v167
    v_pk_mul_f32 v[160:161], v[160:161], v[76:77]
    v_pk_mul_f32 v[162:163], v[162:163], v[78:79]
    v_pk_mul_f32 v[164:165], v[164:165], v[80:81]
    v_pk_mul_f32 v[166:167], v[166:167], v[82:83]
    v_cvt_pk_bf16_f32 v176, v160, v161
    v_cvt_pk_bf16_f32 v177, v162, v163
    v_cvt_pk_bf16_f32 v178, v164, v165
    v_cvt_pk_bf16_f32 v179, v166, v167
    buffer_store_dwordx4 v[176:179], v18, s[40:43], s50 offen offset:2048 sc1
    v_pk_mul_f32 v[160:161], v[84:85], v[84:85]
    v_pk_mul_f32 v[162:163], v[86:87], v[86:87]
    v_pk_mul_f32 v[164:165], v[88:89], v[88:89]
    v_pk_mul_f32 v[166:167], v[90:91], v[90:91]
    v_pk_fma_f32 v[160:161], v[160:161], s[48:49], v[56:57]
    v_pk_fma_f32 v[162:163], v[162:163], s[48:49], v[56:57]
    v_pk_fma_f32 v[164:165], v[164:165], s[48:49], v[56:57]
    v_pk_fma_f32 v[166:167], v[166:167], s[48:49], v[56:57]
    v_pk_mul_f32 v[160:161], v[160:161], v[84:85]
    v_pk_mul_f32 v[162:163], v[162:163], v[86:87]
    v_pk_mul_f32 v[164:165], v[164:165], v[88:89]
    v_pk_mul_f32 v[166:167], v[166:167], v[90:91]
    v_exp_f32 v160, v160
    v_exp_f32 v161, v161
    v_exp_f32 v162, v162
    v_exp_f32 v163, v163
    v_exp_f32 v164, v164
    v_exp_f32 v165, v165
    v_exp_f32 v166, v166
    v_exp_f32 v167, v167
    v_pk_add_f32 v[160:161], v[160:161], 1.0 op_sel_hi:[1,0]
    v_pk_add_f32 v[162:163], v[162:163], 1.0 op_sel_hi:[1,0]
    v_pk_add_f32 v[164:165], v[164:165], 1.0 op_sel_hi:[1,0]
    v_pk_add_f32 v[166:167], v[166:167], 1.0 op_sel_hi:[1,0]
    v_rcp_f32 v160, v160
    v_rcp_f32 v161, v161
    v_rcp_f32 v162, v162
    v_rcp_f32 v163, v163
    v_rcp_f32 v164, v164
    v_rcp_f32 v165, v165
    v_rcp_f32 v166, v166
    v_rcp_f32 v167, v167
    v_pk_mul_f32 v[160:161], v[160:161], v[84:85]
    v_pk_mul_f32 v[162:163], v[162:163], v[86:87]
    v_pk_mul_f32 v[164:165], v[164:165], v[88:89]
    v_pk_mul_f32 v[166:167], v[166:167], v[90:91]
    v_cvt_pk_bf16_f32 v180, v160, v161
    v_cvt_pk_bf16_f32 v181, v162, v163
    v_cvt_pk_bf16_f32 v182, v164, v165
    v_cvt_pk_bf16_f32 v183, v166, v167
    buffer_store_dwordx4 v[180:183], v18, s[40:43], s50 offen offset:3072 sc1
    v_pk_mul_f32 v[160:161], v[92:93], v[92:93]
    v_pk_mul_f32 v[162:163], v[94:95], v[94:95]
    v_pk_mul_f32 v[164:165], v[96:97], v[96:97]
    v_pk_mul_f32 v[166:167], v[98:99], v[98:99]
    v_pk_fma_f32 v[160:161], v[160:161], s[48:49], v[56:57]
    v_pk_fma_f32 v[162:163], v[162:163], s[48:49], v[56:57]
    v_pk_fma_f32 v[164:165], v[164:165], s[48:49], v[56:57]
    v_pk_fma_f32 v[166:167], v[166:167], s[48:49], v[56:57]
    v_pk_mul_f32 v[160:161], v[160:161], v[92:93]
    v_pk_mul_f32 v[162:163], v[162:163], v[94:95]
    v_pk_mul_f32 v[164:165], v[164:165], v[96:97]
    v_pk_mul_f32 v[166:167], v[166:167], v[98:99]
    v_exp_f32 v160, v160
    v_exp_f32 v161, v161
    v_exp_f32 v162, v162
    v_exp_f32 v163, v163
    v_exp_f32 v164, v164
    v_exp_f32 v165, v165
    v_exp_f32 v166, v166
    v_exp_f32 v167, v167
    v_pk_add_f32 v[160:161], v[160:161], 1.0 op_sel_hi:[1,0]
    v_pk_add_f32 v[162:163], v[162:163], 1.0 op_sel_hi:[1,0]
    v_pk_add_f32 v[164:165], v[164:165], 1.0 op_sel_hi:[1,0]
    v_pk_add_f32 v[166:167], v[166:167], 1.0 op_sel_hi:[1,0]
    v_rcp_f32 v160, v160
    v_rcp_f32 v161, v161
    v_rcp_f32 v162, v162
    v_rcp_f32 v163, v163
    v_rcp_f32 v164, v164
    v_rcp_f32 v165, v165
    v_rcp_f32 v166, v166
    v_rcp_f32 v167, v167
    v_pk_mul_f32 v[160:161], v[160:161], v[92:93]
    v_pk_mul_f32 v[162:163], v[162:163], v[94:95]
    v_pk_mul_f32 v[164:165], v[164:165], v[96:97]
    v_pk_mul_f32 v[166:167], v[166:167], v[98:99]
    v_cvt_pk_bf16_f32 v184, v160, v161
    v_cvt_pk_bf16_f32 v185, v162, v163
    v_cvt_pk_bf16_f32 v186, v164, v165
    v_cvt_pk_bf16_f32 v187, v166, v167
    buffer_store_dwordx4 v[184:187], v18, s[40:43], s51 offen offset:0 sc1
    v_pk_mul_f32 v[160:161], v[100:101], v[100:101]
    v_pk_mul_f32 v[162:163], v[102:103], v[102:103]
    v_pk_mul_f32 v[164:165], v[104:105], v[104:105]
    v_pk_mul_f32 v[166:167], v[106:107], v[106:107]
    v_pk_fma_f32 v[160:161], v[160:161], s[48:49], v[56:57]
    v_pk_fma_f32 v[162:163], v[162:163], s[48:49], v[56:57]
    v_pk_fma_f32 v[164:165], v[164:165], s[48:49], v[56:57]
    v_pk_fma_f32 v[166:167], v[166:167], s[48:49], v[56:57]
    v_pk_mul_f32 v[160:161], v[160:161], v[100:101]
    v_pk_mul_f32 v[162:163], v[162:163], v[102:103]
    v_pk_mul_f32 v[164:165], v[164:165], v[104:105]
    v_pk_mul_f32 v[166:167], v[166:167], v[106:107]
    v_exp_f32 v160, v160
    v_exp_f32 v161, v161
    v_exp_f32 v162, v162
    v_exp_f32 v163, v163
    v_exp_f32 v164, v164
    v_exp_f32 v165, v165
    v_exp_f32 v166, v166
    v_exp_f32 v167, v167
    v_pk_add_f32 v[160:161], v[160:161], 1.0 op_sel_hi:[1,0]
    v_pk_add_f32 v[162:163], v[162:163], 1.0 op_sel_hi:[1,0]
    v_pk_add_f32 v[164:165], v[164:165], 1.0 op_sel_hi:[1,0]
    v_pk_add_f32 v[166:167], v[166:167], 1.0 op_sel_hi:[1,0]
    v_rcp_f32 v160, v160
    v_rcp_f32 v161, v161
    v_rcp_f32 v162, v162
    v_rcp_f32 v163, v163
    v_rcp_f32 v164, v164
    v_rcp_f32 v165, v165
    v_rcp_f32 v166, v166
    v_rcp_f32 v167, v167
    v_pk_mul_f32 v[160:161], v[160:161], v[100:101]
    v_pk_mul_f32 v[162:163], v[162:163], v[102:103]
    v_pk_mul_f32 v[164:165], v[164:165], v[104:105]
    v_pk_mul_f32 v[166:167], v[166:167], v[106:107]
    v_cvt_pk_bf16_f32 v188, v160, v161
    v_cvt_pk_bf16_f32 v189, v162, v163
    v_cvt_pk_bf16_f32 v190, v164, v165
    v_cvt_pk_bf16_f32 v191, v166, v167
    buffer_store_dwordx4 v[188:191], v18, s[40:43], s51 offen offset:1024 sc1
    s_barrier
L_LASTF:
    ds_read_b64_tr_b16 v[240:241], v10 offset:49152
    ds_read_b64_tr_b16 v[242:243], v10 offset:51200
    ds_read_b64_tr_b16 v[244:245], v11 offset:49152
    ds_read_b64_tr_b16 v[246:247], v11 offset:51200
    ds_read_b64_tr_b16 v[248:249], v12 offset:49152
    ds_read_b64_tr_b16 v[250:251], v12 offset:51200
    ds_read_b64_tr_b16 v[252:253], v13 offset:49152
    ds_read_b64_tr_b16 v[254:255], v13 offset:51200
    v_lshlrev_b32 v36, 16, v32
    v_and_b32 v37, 0xffff0000, v32
    v_lshlrev_b32 v38, 16, v33
    v_and_b32 v39, 0xffff0000, v33
    v_lshlrev_b32 v40, 16, v34
    v_and_b32 v41, 0xffff0000, v34
    v_lshlrev_b32 v42, 16, v35
    v_and_b32 v43, 0xffff0000, v35
    s_waitcnt vmcnt(0)
    buffer_store_dword v55, v52, s[40:43], s66 offen sc1
L_C2:
    buffer_load_dword v28, v26, s[40:43], s63 offen sc1
    v_mov_b32 v27, 0
    s_waitcnt lgkmcnt(0)
    s_barrier
L_PHASE2:
    s_mov_b32 s67, 0
L_CN:
    v_readlane_b32 s62, v24, s25
    s_add_u32 s67, s67, 1
    s_nop 1
    s_cmp_eq_u32 s62, 0
    s_cbranch_scc1 L_CN_RETRY
L_CN_OK:
    s_sub_u32 s62, s62, 1
    v_subrev_u32 v29, s62, v27
    v_subrev_u32 v29, 3, v29
    v_cmp_ge_u32 vcc, 0, v29
    s_nop 1
    s_and_b32 s31, vcc_lo, s56
    s_cmp_eq_u32 s31, s56
    s_cbranch_scc1 L_GO
L_POLL:
    s_waitcnt vmcnt(0)
    v_subrev_u32 v29, s62, v28
    v_subrev_u32 v29, 3, v29
    v_cmp_ge_u32 vcc, 0, v29
    s_nop 1
    s_and_b32 s31, vcc_lo, s56
    s_cmp_eq_u32 s31, s56
    s_cbranch_scc1 L_GO
    s_add_u32 s67, s67, 1
    s_sleep 2
    buffer_load_dword v28, v26, s[40:43], s63 offen sc1
    s_cmp_le_u32 s67, 1048576
    s_cbranch_scc1 L_POLL
L_GO:
    s_add_u32 s66, s27, 0
    s_lshl_b32 s66, s66, 11
    buffer_load_dwordx4 v[60:63], v18, s[36:39], s66 offen offset:0 sc1
    buffer_load_dwordx4 v[64:67], v18, s[36:39], s66 offen offset:1024 sc1
    s_add_u32 s66, s27, 1
    s_lshl_b32 s66, s66, 11
    buffer_load_dwordx4 v[68:71], v18, s[36:39], s66 offen offset:0 sc1
    buffer_load_dwordx4 v[72:75], v18, s[36:39], s66 offen offset:1024 sc1
    s_add_u32 s66, s27, 2
    s_lshl_b32 s66, s66, 11
    buffer_load_dwordx4 v[76:79], v18, s[36:39], s66 offen offset:0 sc1
    buffer_load_dwordx4 v[80:83], v18, s[36:39], s66 offen offset:1024 sc1
    ds_read_b64_tr_b16 v[224:225], v14 offset:0
    ds_read_b64_tr_b16 v[226:227], v14 offset:2048
    ds_read_b64_tr_b16 v[228:229], v15 offset:0
    ds_read_b64_tr_b16 v[230:231], v15 offset:2048
    ds_read_b64_tr_b16 v[232:233], v16 offset:0
    ds_read_b64_tr_b16 v[234:235], v16 offset:2048
    ds_read_b64_tr_b16 v[236:237], v17 offset:0
    ds_read_b64_tr_b16 v[238:239], v17 offset:2048
    s_waitcnt vmcnt(5)
    v_mfma_f32_16x16x32_bf16 v[192:195], v[240:243], v[60:63], 0
    ds_read_b64_tr_b16 v[168:169], v14 offset:16384
    v_mfma_f32_16x16x32_bf16 v[200:203], v[244:247], v[60:63], 0
    ds_read_b64_tr_b16 v[170:171], v14 offset:18432
    v_mfma_f32_16x16x32_bf16 v[208:211], v[248:251], v[60:63], 0
    ds_read_b64_tr_b16 v[172:173], v15 offset:16384
    v_mfma_f32_16x16x32_bf16 v[216:219], v[252:255], v[60:63], 0
    ds_read_b64_tr_b16 v[174:175], v15 offset:18432
    s_add_u32 s66, s27, 3
    s_lshl_b32 s66, s66, 11
    buffer_load_dwordx4 v[84:87], v18, s[36:39], s66 offen offset:0 sc1
    s_waitcnt vmcnt(5)
    v_mfma_f32_16x16x32_bf16 v[196:199], v[240:243], v[64:67], 0
    ds_read_b64_tr_b16 v[176:177], v16 offset:16384
    v_mfma_f32_16x16x32_bf16 v[204:207], v[244:247], v[64:67], 0
    ds_read_b64_tr_b16 v[178:179], v16 offset:18432
    v_mfma_f32_16x16x32_bf16 v[212:215], v[248:251], v[64:67], 0
    ds_read_b64_tr_b16 v[180:181], v17 offset:16384
    v_mfma_f32_16x16x32_bf16 v[220:223], v[252:255], v[64:67], 0
    ds_read_b64_tr_b16 v[182:183], v17 offset:18432
    buffer_load_dwordx4 v[88:91], v18, s[36:39], s66 offen offset:1024 sc1
    s_waitcnt vmcnt(5) lgkmcnt(8)
    v_mfma_f32_16x16x32_bf16 v[192:195], v[224:227], v[68:71], v[192:195]
    ds_read_b64_tr_b16 v[240:241], v6 offset:0
    v_mfma_f32_16x16x32_bf16 v[200:203], v[228:231], v[68:71], v[200:203]
    ds_read_b64_tr_b16 v[242:243], v6 offset:2048
    v_mfma_f32_16x16x32_bf16 v[208:211], v[232:235], v[68:71], v[208:211]
    ds_read_b64_tr_b16 v[244:245], v7 offset:0
    v_mfma_f32_16x16x32_bf16 v[216:219], v[236:239], v[68:71], v[216:219]
    ds_read_b64_tr_b16 v[246:247], v7 offset:2048
    s_add_u32 s66, s27, 4
    s_lshl_b32 s66, s66, 11
    buffer_load_dwordx4 v[92:95], v18, s[36:39], s66 offen offset:0 sc1
    s_waitcnt vmcnt(5)
    v_mfma_f32_16x16x32_bf16 v[196:199], v[224:227], v[72:75], v[196:199]
    ds_read_b64_tr_b16 v[248:249], v8 offset:0
    v_mfma_f32_16x16x32_bf16 v[204:207], v[228:231], v[72:75], v[204:207]
    ds_read_b64_tr_b16 v[250:251], v8 offset:2048
    v_mfma_f32_16x16x32_bf16 v[212:215], v[232:235], v[72:75], v[212:215]
    ds_read_b64_tr_b16 v[252:253], v9 offset:0
    v_mfma_f32_16x16x32_bf16 v[220:223], v[236:239], v[72:75], v[220:223]
    ds_read_b64_tr_b16 v[254:255], v9 offset:2048
    buffer_load_dwordx4 v[96:99], v18, s[36:39], s66 offen offset:1024 sc1
    s_waitcnt vmcnt(5) lgkmcnt(8)
    v_mfma_f32_16x16x32_bf16 v[192:195], v[168:171], v[76:79], v[192:195]
    ds_read_b64_tr_b16 v[224:225], v6 offset:16384
    v_mfma_f32_16x16x32_bf16 v[200:203], v[172:175], v[76:79], v[200:203]
    ds_read_b64_tr_b16 v[226:227], v6 offset:18432
    v_mfma_f32_16x16x32_bf16 v[208:211], v[176:179], v[76:79], v[208:211]
    ds_read_b64_tr_b16 v[228:229], v7 offset:16384
    v_mfma_f32_16x16x32_bf16 v[216:219], v[180:183], v[76:79], v[216:219]
    ds_read_b64_tr_b16 v[230:231], v7 offset:18432
    s_add_u32 s66, s27, 5
    s_lshl_b32 s66, s66, 11
    buffer_load_dwordx4 v[100:103], v18, s[36:39], s66 offen offset:0 sc1
    s_waitcnt vmcnt(5)
    v_mfma_f32_16x16x32_bf16 v[196:199], v[168:171], v[80:83], v[196:199]
    ds_read_b64_tr_b16 v[232:233], v8 offset:16384
    v_mfma_f32_16x16x32_bf16 v[204:207], v[172:175], v[80:83], v[204:207]
    ds_read_b64_tr_b16 v[234:235], v8 offset:18432
    v_mfma_f32_16x16x32_bf16 v[212:215], v[176:179], v[80:83], v[212:215]
    ds_read_b64_tr_b16 v[236:237], v9 offset:16384
    v_mfma_f32_16x16x32_bf16 v[220:223], v[180:183], v[80:83], v[220:223]
    ds_read_b64_tr_b16 v[238:239], v9 offset:18432
    buffer_load_dwordx4 v[104:107], v18, s[36:39], s66 offen offset:1024 sc1
    s_waitcnt lgkmcnt(0)
    s_barrier
    s_waitcnt vmcnt(5) lgkmcnt(8)
    v_mfma_f32_16x16x32_bf16 v[192:195], v[240:243], v[84:87], v[192:195]
    ds_read_b64_tr_b16 v[168:169], v6 offset:32768
    v_mfma_f32_16x16x32_bf16 v[200:203], v[244:247], v[84:87], v[200:203]
    ds_read_b64_tr_b16 v[170:171], v6 offset:34816
    v_mfma_f32_16x16x32_bf16 v[208:211], v[248:251], v[84:87], v[208:211]
    ds_read_b64_tr_b16 v[172:173], v7 offset:32768
    v_mfma_f32_16x16x32_bf16 v[216:219], v[252:255], v[84:87], v[216:219]
    ds_read_b64_tr_b16 v[174:175], v7 offset:34816
    s_add_u32 s66, s27, 6
    s_lshl_b32 s66, s66, 11
    buffer_load_dwordx4 v[108:111], v18, s[36:39], s66 offen offset:0 sc1
    s_waitcnt vmcnt(5)
    v_mfma_f32_16x16x32_bf16 v[196:199], v[240:243], v[88:91], v[196:199]
    ds_read_b64_tr_b16 v[176:177], v8 offset:32768
    v_mfma_f32_16x16x32_bf16 v[204:207], v[244:247], v[88:91], v[204:207]
    ds_read_b64_tr_b16 v[178:179], v8 offset:34816
    v_mfma_f32_16x16x32_bf16 v[212:215], v[248:251], v[88:91], v[212:215]
    ds_read_b64_tr_b16 v[180:181], v9 offset:32768
    v_mfma_f32_16x16x32_bf16 v[220:223], v[252:255], v[88:91], v[220:223]
    ds_read_b64_tr_b16 v[182:183], v9 offset:34816
    buffer_load_dwordx4 v[112:115], v18, s[36:39], s66 offen offset:1024 sc1
    s_waitcnt vmcnt(5) lgkmcnt(8)
    v_mfma_f32_16x16x32_bf16 v[192:195], v[224:227], v[92:95], v[192:195]
    ds_read_b64_tr_b16 v[240:241], v6 offset:49152
    v_mfma_f32_16x16x32_bf16 v[200:203], v[228:231], v[92:95], v[200:203]
    ds_read_b64_tr_b16 v[242:243], v6 offset:51200
    v_mfma_f32_16x16x32_bf16 v[208:211], v[232:235], v[92:95], v[208:211]
    ds_read_b64_tr_b16 v[244:245], v7 offset:49152
    v_mfma_f32_16x16x32_bf16 v[216:219], v[236:239], v[92:95], v[216:219]
    ds_read_b64_tr_b16 v[246:247], v7 offset:51200
    s_add_u32 s66, s27, 7
    s_lshl_b32 s66, s66, 11
    buffer_load_dwordx4 v[116:119], v18, s[36:39], s66 offen offset:0 sc1
    s_waitcnt vmcnt(5)
    v_mfma_f32_16x16x32_bf16 v[196:199], v[224:227], v[96:99], v[196:199]
    ds_read_b64_tr_b16 v[248:249], v8 offset:49152
    v_mfma_f32_16x16x32_bf16 v[204:207], v[228:231], v[96:99], v[204:207]
    ds_read_b64_tr_b16 v[250:251], v8 offset:51200
    v_mfma_f32_16x16x32_bf16 v[212:215], v[232:235], v[96:99], v[212:215]
    ds_read_b64_tr_b16 v[252:253], v9 offset:49152
    v_mfma_f32_16x16x32_bf16 v[220:223], v[236:239], v[96:99], v[220:223]
    ds_read_b64_tr_b16 v[254:255], v9 offset:51200
    buffer_load_dwordx4 v[120:123], v18, s[36:39], s66 offen offset:1024 sc1
    s_waitcnt vmcnt(5) lgkmcnt(8)
    v_mfma_f32_16x16x32_bf16 v[192:195], v[168:171], v[100:103], v[192:195]
    ds_read_b64_tr_b16 v[224:225], v10 offset:0
    v_mfma_f32_16x16x32_bf16 v[200:203], v[172:175], v[100:103], v[200:203]
    ds_read_b64_tr_b16 v[226:227], v10 offset:2048
    v_mfma_f32_16x16x32_bf16 v[208:211], v[176:179], v[100:103], v[208:211]
    ds_read_b64_tr_b16 v[228:229], v11 offset:0
    v_mfma_f32_16x16x32_bf16 v[216:219], v[180:183], v[100:103], v[216:219]
    ds_read_b64_tr_b16 v[230:231], v11 offset:2048
    s_add_u32 s66, s27, 8
    s_lshl_b32 s66, s66, 11
    s_add_u32 s64, s66, 4096
    buffer_load_dwordx4 v[124:127], v18, s[36:39], s66 offen offset:0 sc1
    s_waitcnt vmcnt(5)
    v_mfma_f32_16x16x32_bf16 v[196:199], v[168:171], v[104:107], v[196:199]
    ds_read_b64_tr_b16 v[232:233], v12 offset:0
    v_mfma_f32_16x16x32_bf16 v[204:207], v[172:175], v[104:107], v[204:207]
    ds_read_b64_tr_b16 v[234:235], v12 offset:2048
    v_mfma_f32_16x16x32_bf16 v[212:215], v[176:179], v[104:107], v[212:215]
    ds_read_b64_tr_b16 v[236:237], v13 offset:0
    v_mfma_f32_16x16x32_bf16 v[220:223], v[180:183], v[104:107], v[220:223]
    ds_read_b64_tr_b16 v[238:239], v13 offset:2048
    buffer_load_dwordx4 v[132:135], v18, s[36:39], s66 offen offset:2048 sc1
    s_waitcnt vmcnt(5) lgkmcnt(8)
    v_mfma_f32_16x16x32_bf16 v[192:195], v[240:243], v[108:111], v[192:195]
    ds_read_b64_tr_b16 v[168:169], v10 offset:16384
    v_mfma_f32_16x16x32_bf16 v[200:203], v[244:247], v[108:111], v[200:203]
    ds_read_b64_tr_b16 v[170:171], v10 offset:18432
    v_mfma_f32_16x16x32_bf16 v[208:211], v[248:251], v[108:111], v[208:211]
    ds_read_b64_tr_b16 v[172:173], v11 offset:16384
    v_mfma_f32_16x16x32_bf16 v[216:219], v[252:255], v[108:111], v[216:219]
    ds_read_b64_tr_b16 v[174:175], v11 offset:18432
    buffer_load_dwordx4 v[140:143], v18, s[36:39], s64 offen offset:0 sc1
    s_waitcnt vmcnt(5)
    v_mfma_f32_16x16x32_bf16 v[196:199], v[240:243], v[112:115], v[196:199]
    ds_read_b64_tr_b16 v[176:177], v12 offset:16384
    v_mfma_f32_16x16x32_bf16 v[204:207], v[244:247], v[112:115], v[204:207]
    ds_read_b64_tr_b16 v[178:179], v12 offset:18432
    v_mfma_f32_16x16x32_bf16 v[212:215], v[248:251], v[112:115], v[212:215]
    ds_read_b64_tr_b16 v[180:181], v13 offset:16384
    v_mfma_f32_16x16x32_bf16 v[220:223], v[252:255], v[112:115], v[220:223]
    ds_read_b64_tr_b16 v[182:183], v13 offset:18432
    buffer_load_dwordx4 v[128:131], v18, s[36:39], s66 offen offset:1024 sc1
    s_waitcnt vmcnt(5) lgkmcnt(8)
    v_mfma_f32_16x16x32_bf16 v[192:195], v[224:227], v[116:119], v[192:195]
    ds_read_b64_tr_b16 v[240:241], v10 offset:32768
    v_mfma_f32_16x16x32_bf16 v[200:203], v[228:231], v[116:119], v[200:203]
    ds_read_b64_tr_b16 v[242:243], v10 offset:34816
    v_mfma_f32_16x16x32_bf16 v[208:211], v[232:235], v[116:119], v[208:211]
    ds_read_b64_tr_b16 v[244:245], v11 offset:32768
    v_mfma_f32_16x16x32_bf16 v[216:219], v[236:239], v[116:119], v[216:219]
    ds_read_b64_tr_b16 v[246:247], v11 offset:34816
    buffer_load_dwordx4 v[136:139], v18, s[36:39], s66 offen offset:3072 sc1
    s_waitcnt vmcnt(5)
    v_mfma_f32_16x16x32_bf16 v[196:199], v[224:227], v[120:123], v[196:199]
    ds_read_b64_tr_b16 v[248:249], v12 offset:32768
    v_mfma_f32_16x16x32_bf16 v[204:207], v[228:231], v[120:123], v[204:207]
    ds_read_b64_tr_b16 v[250:251], v12 offset:34816
    v_mfma_f32_16x16x32_bf16 v[212:215], v[232:235], v[120:123], v[212:215]
    ds_read_b64_tr_b16 v[252:253], v13 offset:32768
    v_mfma_f32_16x16x32_bf16 v[220:223], v[236:239], v[120:123], v[220:223]
    ds_read_b64_tr_b16 v[254:255], v13 offset:34816
    buffer_load_dwordx4 v[144:147], v18, s[36:39], s64 offen offset:1024 sc1
    s_waitcnt vmcnt(5) lgkmcnt(8)
    v_mfma_f32_16x16x32_bf16 v[192:195], v[168:171], v[124:127], v[192:195]
    ds_read_b64_tr_b16 v[224:225], v10 offset:49152
    ds_read_b64_tr_b16 v[226:227], v10 offset:51200
    v_mfma_f32_16x16x32_bf16 v[200:203], v[172:175], v[124:127], v[200:203]
    ds_read_b64_tr_b16 v[228:229], v11 offset:49152
    ds_read_b64_tr_b16 v[230:231], v11 offset:51200
    v_mfma_f32_16x16x32_bf16 v[208:211], v[176:179], v[124:127], v[208:211]
    ds_read_b64_tr_b16 v[232:233], v12 offset:49152
    ds_read_b64_tr_b16 v[234:235], v12 offset:51200
    v_mfma_f32_16x16x32_bf16 v[216:219], v[180:183], v[124:127], v[216:219]
    ds_read_b64_tr_b16 v[236:237], v13 offset:49152
    ds_read_b64_tr_b16 v[238:239], v13 offset:51200
    s_waitcnt vmcnt(4) lgkmcnt(8)
    v_mfma_f32_16x16x32_bf16 v[192:195], v[240:243], v[132:135], v[192:195]
    v_mfma_f32_16x16x32_bf16 v[200:203], v[244:247], v[132:135], v[200:203]
    v_mfma_f32_16x16x32_bf16 v[208:211], v[248:251], v[132:135], v[208:211]
    v_mfma_f32_16x16x32_bf16 v[216:219], v[252:255], v[132:135], v[216:219]
    s_waitcnt vmcnt(3) lgkmcnt(0)
    v_mfma_f32_16x16x32_bf16 v[192:195], v[224:227], v[140:143], v[192:195]
    v_mfma_f32_16x16x32_bf16 v[200:203], v[228:231], v[140:143], v[200:203]
    v_mfma_f32_16x16x32_bf16 v[208:211], v[232:235], v[140:143], v[208:211]
    v_mfma_f32_16x16x32_bf16 v[216:219], v[236:239], v[140:143], v[216:219]
    s_waitcnt vmcnt(0)
    v_mfma_f32_16x16x32_bf16 v[196:199], v[168:171], v[128:131], v[196:199]
    v_mfma_f32_16x16x32_bf16 v[196:199], v[240:243], v[136:139], v[196:199]
    v_mfma_f32_16x16x32_bf16 v[196:199], v[224:227], v[144:147], v[196:199]
    v_mfma_f32_16x16x32_bf16 v[204:207], v[172:175], v[128:131], v[204:207]
    ds_write_b128 v19, v[192:195] offset:0
    v_mfma_f32_16x16x32_bf16 v[204:207], v[244:247], v[136:139], v[204:207]
    ds_write_b128 v20, v[200:203] offset:0
    v_mfma_f32_16x16x32_bf16 v[204:207], v[228:231], v[144:147], v[204:207]
    ds_write_b128 v19, v[208:211] offset:128
    v_mfma_f32_16x16x32_bf16 v[212:215], v[176:179], v[128:131], v[212:215]
    ds_write_b128 v20, v[216:219] offset:128
    v_mfma_f32_16x16x32_bf16 v[212:215], v[248:251], v[136:139], v[212:215]
    ds_write_b128 v19, v[196:199] offset:4096
    v_mfma_f32_16x16x32_bf16 v[212:215], v[232:235], v[144:147], v[212:215]
    v_mfma_f32_16x16x32_bf16 v[220:223], v[180:183], v[128:131], v[220:223]
    v_mfma_f32_16x16x32_bf16 v[220:223], v[252:255], v[136:139], v[220:223]
    v_mfma_f32_16x16x32_bf16 v[220:223], v[236:239], v[144:147], v[220:223]
    ds_write_b128 v20, v[204:207] offset:4096
    s_nop 3
    ds_write_b128 v19, v[212:215] offset:4224
    s_nop 1
    ds_write_b128 v20, v[220:223] offset:4224
    s_waitcnt lgkmcnt(0)
    s_barrier
    ds_read_b128 v[60:63], v21 offset:0
    ds_read_b128 v[64:67], v22 offset:0
    ds_read_b128 v[68:71], v21 offset:8192
    ds_read_b128 v[72:75], v22 offset:8192
    ds_read_b128 v[76:79], v21 offset:16384
    ds_read_b128 v[80:83], v22 offset:16384
    ds_read_b128 v[84:87], v21 offset:24576
    ds_read_b128 v[88:91], v22 offset:24576
    s_waitcnt lgkmcnt(6)
    v_pk_add_f32 v[36:37], v[36:37], v[60:61]
    v_pk_add_f32 v[38:39], v[38:39], v[62:63]
    v_pk_add_f32 v[40:41], v[40:41], v[64:65]
    v_pk_add_f32 v[42:43], v[42:43], v[66:67]
    s_waitcnt lgkmcnt(4)
    v_pk_add_f32 v[36:37], v[36:37], v[68:69]
    v_pk_add_f32 v[38:39], v[38:39], v[70:71]
    v_pk_add_f32 v[40:41], v[40:41], v[72:73]
    v_pk_add_f32 v[42:43], v[42:43], v[74:75]
    s_waitcnt lgkmcnt(2)
    v_pk_add_f32 v[36:37], v[36:37], v[76:77]
    v_pk_add_f32 v[38:39], v[38:39], v[78:79]
    v_pk_add_f32 v[40:41], v[40:41], v[80:81]
    v_pk_add_f32 v[42:43], v[42:43], v[82:83]
    s_waitcnt lgkmcnt(0)
    v_pk_add_f32 v[36:37], v[36:37], v[84:85]
    v_pk_add_f32 v[38:39], v[38:39], v[86:87]
    v_pk_add_f32 v[40:41], v[40:41], v[88:89]
    v_pk_add_f32 v[42:43], v[42:43], v[90:91]
    v_cvt_pk_bf16_f32 v224, v36, v37
    v_cvt_pk_bf16_f32 v225, v38, v39
    v_cvt_pk_bf16_f32 v226, v40, v41
    v_cvt_pk_bf16_f32 v227, v42, v43
    buffer_store_dwordx4 v[224:227], v23, s[52:55], 0 offen sc1
L_END:
    s_endpgm
.section .rodata,"a"
.p2align 6
.amdhsa_kernel standalone__dense_activation_gelu__prompt_kernel
  .amdhsa_next_free_vgpr 256
  .amdhsa_next_free_sgpr 102
  .amdhsa_accum_offset 256
  .amdhsa_group_segment_fixed_size 0
  .amdhsa_kernarg_size 64
  .amdhsa_user_sgpr_count 2
  .amdhsa_user_sgpr_kernarg_segment_ptr 1
  .amdhsa_system_sgpr_workgroup_id_x 1
  .amdhsa_float_denorm_mode_32 3
.end_amdhsa_kernel
```
